```python
import torch

def _softmax(x, axis=-1):
    return torch.softmax(x, dim=axis)
def _gelu(x):
    return torch.nn.functional.gelu(x, approximate="tanh")
def _silu(x):
    return torch.nn.functional.silu(x)
def _sigmoid(x):
    return torch.sigmoid(x)
def _layernorm(x, axis=-1, eps=1e-5):
    m = x.mean(dim=axis, keepdim=True)
    v = x.var(dim=axis, keepdim=True, unbiased=False)
    return (x - m) / torch.sqrt(v + eps)
def _scatter_add(tgt, idx, src, axis=0):
    return tgt.clone().index_add_(axis, idx, src)
def _segment_sum(src, seg, n):
    out = torch.zeros((n,) + src.shape[1:], dtype=src.dtype)
    return out.index_add_(0, seg, src)
def _pad(x, pw):
    flat = tuple(v for pair in reversed(pw) for v in pair)
    return torch.nn.functional.pad(x, flat)

kernel_name = 'parallel_sum__spectral_gfnet__mixer_channel_mlp__prompt'

def setup_inputs():

    _w = (lambda a: (lambda t: t.to(torch.bfloat16) if t.is_floating_point() else t)(torch.as_tensor(a)))
    def _A_setup():
        B, S, D = 1, 2048, 512
        Df = D // 2 + 1
        return {
            "x": _w((lambda *s: torch.randn(*s, dtype=torch.bfloat16) * 0.05)(B, S, D)),
            "w_r": _w((lambda *s: torch.randn(*s, dtype=torch.bfloat16) * 0.8)(S, Df) * 0.02),
            "w_i": _w((lambda *s: torch.randn(*s, dtype=torch.bfloat16) * 0.8)(S, Df) * 0.02),
        }
    _A_in = _A_setup()

    def _B_setup():
        B, S, D, F = 1, 2048, 512, 1792
        return {
            "x": _w((lambda *s: torch.randn(*s, dtype=torch.bfloat16) * 0.05)(B, S, D)),
            "w1": _w((lambda *s: torch.randn(*s, dtype=torch.bfloat16) * 0.8)(D, F) * (D ** -0.5)),
            "b1": _w((lambda *s: torch.randn(*s, dtype=torch.bfloat16) * 0.4)(F)),
            "w2": _w((lambda *s: torch.randn(*s, dtype=torch.bfloat16) * 0.05)(F, D) * (F ** -0.5)),
            "b2": _w((lambda *s: torch.randn(*s, dtype=torch.bfloat16) * 0.05)(D)),
        }
    _B_in = _B_setup()

    return {
        "A_x": _A_in["x"],
        "A_w_r": _A_in["w_r"],
        "A_w_i": _A_in["w_i"],
        "B_x": _B_in["x"],
        "B_w1": _B_in["w1"],
        "B_b1": _B_in["b1"],
        "B_w2": _B_in["w2"],
        "B_b2": _B_in["b2"],
    }

def reference(A_x, A_w_r, A_w_i, B_x, B_w1, B_b1, B_w2, B_b2):
    def _A_ref(x, w_r, w_i):
        B, S, D = x.shape
        X = (lambda x, axes=(-2,-1): torch.fft.rfft2(x.float(), dim=axes))(x, axes=(-2, -1))
        W = w_r + 1j * w_i
        X = X * W
        y = (lambda x, s, axes=(-2,-1): torch.fft.irfft2(x, s=s, dim=axes).to(torch.bfloat16))(X, (S, D), axes=(-2, -1))
        return y

    def _B_ref(x, w1, b1, w2, b2):
        y = _layernorm(x, axis=-1)
        h = _gelu(torch.einsum("bsd,df->bsf", y, w1) + b1)
        return torch.einsum("bsf,fd->bsd", h, w2) + b2

    x = A_x
    xn = _layernorm(x, axis=-1)
    return x + _A_ref(xn, A_w_r, A_w_i) + _B_ref(xn, B_w1, B_b1, B_w2, B_b2)
```

```asm
; @launch grid=(256,1,1) block=(512,1,1) lds=163840
.amdgcn_target "amdgcn-amd-amdhsa--gfx950"
.text
.globl parallel_sum__spectral_gfnet__mixer_channel_mlp__prompt_kernel
.p2align 8
.type parallel_sum__spectral_gfnet__mixer_channel_mlp__prompt_kernel,@function
parallel_sum__spectral_gfnet__mixer_channel_mlp__prompt_kernel:
    s_load_dwordx16 s[20:35], s[0:1], 0
    s_load_dwordx2 s[40:41], s[0:1], 80
    s_load_dwordx2 s[36:37], s[0:1], 64
    s_cmp_ge_u32 s2, 256
    s_cbranch_scc1 Lend
    s_getpc_b64 s[52:53]
Lpc:
    v_lshrrev_b32 v2, 6, v0
    v_and_b32 v0, 63, v0
    s_and_b32 s44, s2, 7
    v_readfirstlane_b32 s46, v2
    s_lshr_b32 s45, s2, 3
    s_and_b32 s47, s45, 3
    s_mov_b32 s54, Lcode_end-Lpc
    s_mov_b32 s55, 0x20000
    s_cmp_lg_u32 s46, 7
    s_cbranch_scc1 Lnopf
    v_lshlrev_b32 v2, 7, v0
    s_lshl_b32 s57, s47, 13
    buffer_load_dword v255, v2, s[52:55], s57 offen
Lnopf:
    v_lshlrev_b32 v1, 4, v0
    s_lshr_b32 s48, s45, 2
    s_and_b32 s49, s44, 1
    s_and_b32 s57, s44, 6
    s_lshl_b32 s57, s57, 1
    s_add_u32 s47, s47, s57
    s_lshl_b32 s50, s47, 4
    s_add_u32 s50, s50, s48
    s_lshl_b32 s57, s49, 3
    s_add_u32 s50, s50, s57
    s_mov_b32 s11, 0x20000
    s_mul_i32 s62, s49, 7
    s_add_u32 s62, s62, s48
    v_mov_b32 v254, 151552
    s_and_b32 s57, s46, 6
    s_cmp_eq_u32 s57, 4
    s_cbranch_scc1 Lloader
    s_lshl_b32 s51, s44, 5
    s_add_u32 s51, s51, s45
    s_mov_b32 s14, 25165824
    s_mov_b32 s15, 0x20000
    s_mov_b32 s3, 0xffff0000
    s_cmp_ge_u32 s46, 4
    s_cbranch_scc1 Lawld
    s_lshr_b32 s57, s50, 5
    s_lshl_b32 s57, s57, 7
    s_and_b32 s58, s50, 31
    s_add_u32 s57, s57, s58
    s_lshl_b32 s58, s46, 5
    s_add_u32 s57, s57, s58
    s_lshl_b32 s57, s57, 10
    s_lshl_b32 s61, s46, 11
    s_add_u32 s61, s61, 131072
    s_mov_b32 m0, s61
    s_add_u32 s58, s57, 0xffc00
    s_mov_b32 s10, 2097152
    v_mov_b64 v[4:5], 0
    v_mov_b64 v[6:7], 0
    v_add_u32 v3, v1, v254
    ds_write_b128 v3, v[4:7]
    s_waitcnt lgkmcnt(0)
    s_mov_b32 s8, s20
    s_mov_b32 s9, s21
    buffer_load_dwordx4 v1, s[8:11], s57 offen offset:0 lds
    buffer_load_dwordx4 v1, s[8:11], s58 offen offset:1024 lds
    s_mov_b32 s4, s30
    s_mov_b32 s5, s31
    s_mov_b32 s6, 3584
    s_mov_b32 s7, 0x20000
    v_lshlrev_b32 v2, 1, v0
    s_lshl_b32 s57, s62, 8
    s_and_b32 s58, s46, 1
    s_lshl_b32 s58, s58, 7
    s_add_u32 s57, s57, s58
    buffer_load_ushort v198, v2, s[4:7], s57 offen
    s_barrier
    s_branch Lcw
Lawld:
    s_and_b32 s63, s46, 1
    s_waitcnt lgkmcnt(0)
    s_mov_b32 s12, s40
    s_mov_b32 s13, s41
    s_lshl_b32 s57, s2, 1
    s_add_u32 s57, s57, s63
    s_lshl_b32 s57, s57, 7
    v_mov_b32 v4, 0
    buffer_load_dword v253, v4, s[12:15], s57 offen sc1
    s_barrier
    s_branch Law
Lloader:
    s_and_b32 s57, s46, 1
    s_lshl_b32 s56, s57, 14
    s_lshl_b32 s38, s57, 8
    s_add_u32 s38, s38, 151808
    s_mov_b64 s[16:17], s[52:53]
    s_mov_b32 s18, s54
    s_mov_b32 s19, 0x20000
    v_mov_b32 v17, Ltab-Lpc
    v_mov_b64 v[14:15], 0
    v_mov_b32 v16, 0
    s_mov_b32 s14, 25165824
    s_mov_b32 s15, 0x20000
    s_cmp_eq_u32 s48, 7
    s_cbranch_scc1 Lhelper_loader
    s_and_b32 s63, s45, 3
    s_lshl_b32 s63, s63, 1
    s_add_u32 s63, s63, s48
    s_bfe_u32 s57, s44, 0x10001
    s_add_u32 s63, s63, s57
    s_lshl_b32 s57, s49, 2
    s_add_u32 s63, s63, s57
    s_and_b32 s63, s63, 7
    s_mov_b32 s64, 8
    s_mov_b32 s65, 1
    s_mov_b32 s66, 0
    s_cmp_eq_u32 s46, 5
    s_cbranch_scc1 Lld_w
    v_lshrrev_b32 v6, 4, v0
    v_bfe_u32 v7, v0, 3, 1
    v_lshlrev_b32 v7, 20, v7
    v_lshl_add_u32 v7, v6, 15, v7
    v_and_b32 v8, 7, v0
    v_xor_b32 v8, v8, v6
    v_lshl_add_u32 v2, v8, 4, v7
    v_xor_b32 v3, 64, v2
    v_mov_b32 v4, v2
    v_mov_b32 v5, v3
    s_lshr_b32 s59, s47, 1
    s_lshl_b32 s59, s59, 17
    s_and_b32 s57, s47, 1
    s_lshl_b32 s57, s57, 14
    s_add_u32 s59, s59, s57
    s_mov_b32 s60, 128
    s_mov_b32 s61, 4096
    s_mov_b32 s10, 2097152
    s_waitcnt lgkmcnt(0)
    s_mov_b32 s8, s20
    s_mov_b32 s9, s21
    s_branch Lld_go
Lld_w:
    v_bfe_u32 v6, v0, 2, 2
    v_mul_u32_u24 v6, 3584, v6
    v_lshrrev_b32 v7, 4, v0
    v_lshl_add_u32 v6, v7, 6, v6
    v_and_b32 v7, 3, v0
    v_lshl_add_u32 v2, v7, 4, v6
    v_add_u32 v3, 13312, v2
    v_add_u32 v4, 26624, v2
    v_add_u32 v5, 39936, v2
    s_lshl_b32 s59, s62, 8
    s_mov_b32 s60, 229376
    s_mov_b32 s61, 57344
    s_mov_b32 s10, 1835008
    s_waitcnt lgkmcnt(0)
    s_mov_b32 s8, s28
    s_mov_b32 s9, s29
Lld_go:
    s_barrier
Lld_issue:
    s_mul_i32 s67, s63, s60
    s_and_b32 s68, s66, 3
    s_lshl_b32 s68, s68, 15
    s_add_u32 s68, s68, s56
    s_mov_b32 m0, s68
    s_add_u32 s67, s67, s59
    buffer_load_dwordx4 v2, s[8:11], s67 offen offset:0 lds
    buffer_load_dwordx4 v3, s[8:11], s67 offen offset:1024 lds
    buffer_load_dwordx4 v4, s[8:11], s67 offen offset:2048 lds
    buffer_load_dwordx4 v5, s[8:11], s67 offen offset:3072 lds
    s_add_u32 s63, s63, s65
    s_sub_u32 s57, s63, s64
    s_cmp_ge_u32 s63, s64
    s_cselect_b32 s63, s57, s63
    s_add_u32 s68, s68, 4096
    s_mov_b32 m0, s68
    s_add_u32 s67, s67, s61
    buffer_load_dwordx4 v2, s[8:11], s67 offen offset:0 lds
    buffer_load_dwordx4 v3, s[8:11], s67 offen offset:1024 lds
    buffer_load_dwordx4 v4, s[8:11], s67 offen offset:2048 lds
    buffer_load_dwordx4 v5, s[8:11], s67 offen offset:3072 lds
    s_add_u32 s66, s66, 1
    s_lshl_b32 s39, s66, 2
    s_add_u32 s68, s68, 4096
    s_mov_b32 m0, s68
    s_add_u32 s67, s67, s61
    buffer_load_dwordx4 v2, s[8:11], s67 offen offset:0 lds
    buffer_load_dwordx4 v3, s[8:11], s67 offen offset:1024 lds
    buffer_load_dwordx4 v4, s[8:11], s67 offen offset:2048 lds
    buffer_load_dwordx4 v5, s[8:11], s67 offen offset:3072 lds
    s_add_u32 s68, s68, 4096
    s_mov_b32 m0, s68
    s_add_u32 s67, s67, s61
    buffer_load_dwordx4 v2, s[8:11], s67 offen offset:0 lds
    buffer_load_dwordx4 v3, s[8:11], s67 offen offset:1024 lds
    buffer_load_dwordx4 v4, s[8:11], s67 offen offset:2048 lds
    buffer_load_dwordx4 v5, s[8:11], s67 offen offset:3072 lds
    s_mov_b32 m0, s38
    s_nop 0
    buffer_load_dword v17, s[16:19], s39 offen lds
    s_cmp_eq_u32 s66, 1
    s_cbranch_scc1 Lld_b
    s_cmp_eq_u32 s66, 2
    s_cbranch_scc1 Lld_ts
    s_cmp_eq_u32 s66, 4
    s_cbranch_scc1 Lld_pf
Lld_c:
    s_cmp_lt_u32 s66, 4
    s_cbranch_scc1 Lld_issue
    s_cmp_eq_u32 s66, 8
    s_cbranch_scc1 Lld_tail
Lld_b:
    s_barrier
    s_branch Lld_issue
Lld_ts:
    s_load_dwordx2 s[42:43], s[40:41], 0
    s_mov_b32 s12, s40
    s_mov_b32 s13, s41
    s_lshr_b32 s57, s56, 4
    s_lshl_b32 s21, s47, 11
    s_add_u32 s21, s21, s57
    s_add_u32 s21, s21, 524288
    s_add_u32 s22, s21, 30720
    s_add_u32 s23, s57, 155648
    s_lshl_b32 s24, s62, 14
    s_lshr_b32 s58, s47, 2
    s_lshl_b32 s58, s58, 12
    s_add_u32 s24, s24, s58
    s_add_u32 s24, s24, s57
    s_add_u32 s24, s24, 262144
    s_lshl_b32 s51, s44, 5
    s_add_u32 s51, s51, s45
    s_lshr_b32 s3, s51, 7
    s_lshl_b32 s3, s3, 11
    s_add_u32 s3, s3, s57
    s_add_u32 s3, s3, 4096
    v_bfe_u32 v7, v0, 2, 2
    v_lshlrev_b32 v7, 10, v7
    v_lshrrev_b32 v16, 5, v0
    v_lshl_add_u32 v7, v16, 12, v7
    v_bfe_u32 v6, v0, 4, 1
    v_lshl_add_u32 v7, v6, 6, v7
    v_and_b32 v6, 3, v0
    v_lshl_add_u32 v14, v6, 4, v7
    s_mul_i32 s25, s49, 917504
    s_xor_b32 s58, s48, 4
    s_lshl_b32 s58, s58, 7
    s_add_u32 s25, s25, s58
    s_and_b32 s27, s45, 3
    s_lshl_b32 s27, s27, 1
    s_add_u32 s27, s27, s48
    s_and_b32 s57, s46, 1
    s_add_u32 s27, s27, s57
    s_sub_u32 s57, s27, 7
    s_cmp_ge_u32 s27, 7
    s_cselect_b32 s27, s57, s27
    s_sub_u32 s57, s27, 7
    s_cmp_ge_u32 s27, 7
    s_cselect_b32 s27, s57, s27
    v_lshlrev_b32 v16, 5, v16
    v_bfe_u32 v6, v0, 1, 4
    v_add_u32 v16, v16, v6
    v_mul_u32_u24 v16, 8320, v16
    v_and_b32 v6, 1, v0
    v_lshl_add_u32 v16, v6, 4, v16
    s_lshr_b32 s20, s56, 7
    s_mul_i32 s20, s20, 8320
    s_lshl_b32 s58, s51, 5
    s_add_u32 s20, s20, s58
    s_add_u32 s20, s20, 1048576
    v_and_b32 v15, 31, v0
    v_lshlrev_b32 v15, 3, v15
    s_lshr_b32 s26, s51, 6
    s_lshl_b32 s26, s26, 8
    s_add_u32 s26, s26, 12288
    s_cmp_eq_u32 s48, 7
    s_cbranch_scc1 Lld_hs
    s_barrier
    s_branch Lld_issue
Lld_hs:
Lls1:
    s_sleep 4
    ds_read_b128 v[20:23], v254 offset:16
    s_waitcnt lgkmcnt(0)
    v_min3_u32 v20, v20, v21, v22
    v_min_u32 v20, v20, v23
    s_nop 0
    v_readfirstlane_b32 s58, v20
    s_add_u32 s55, s55, 1
    s_lshr_b32 s54, s55, 24
    s_lshl_b32 s54, s54, 8
    s_or_b32 s58, s58, s54
    s_cmp_lt_u32 s58, 8
    s_cbranch_scc1 Lls1
    s_mov_b32 s66, 8
    s_branch Lld_tail2
Lld_pf:
    s_mov_b32 s4, s32
    s_mov_b32 s5, s33
    s_mov_b32 s6, 1835008
    s_mov_b32 s7, 0x20000
    v_lshlrev_b32 v9, 7, v0
    s_mul_i32 s57, s49, 28
    s_add_u32 s57, s57, s45
    s_lshl_b32 s58, s57, 15
    s_add_u32 s58, s58, s56
    s_bfe_u32 s57, s44, 0x10001
    s_lshl_b32 s57, s57, 13
    s_add_u32 s58, s58, s57
    buffer_load_dword v27, v9, s[4:7], s58 offen
    s_branch Lld_c
Lld_tail:
    s_mov_b32 s12, s40
    s_mov_b32 s13, s41
    s_mov_b32 m0, s23
    s_add_u32 s23, s23, 4096
    buffer_load_dwordx4 v1, s[12:15], s21 offen sc1 lds
    buffer_load_dwordx4 v1, s[12:15], s22 offen offset:2048 sc1 lds
    s_mov_b32 m0, s23
    s_nop 0
    buffer_load_dwordx4 v1, s[12:15], s24 offen sc1 lds
    buffer_load_dwordx4 v1, s[12:15], s24 offen offset:2048 sc1 lds
    s_mov_b32 m0, s38
    s_nop 0
    buffer_load_dword v17, s[16:19], 36 offen lds
Lld_tail2:
    buffer_load_dwordx4 v[8:11], v1, s[12:15], s3 offen sc1
    v_mov_b32 v2, v14
    v_add_u32 v3, 7168, v2
    v_add_u32 v4, 14336, v2
    v_add_u32 v5, 21504, v2
    s_mov_b32 s8, s32
    s_mov_b32 s9, s33
    s_mov_b32 s10, 1835008
    s_mov_b32 s59, s25
    s_mov_b32 s60, 131072
    s_mov_b32 s61, 32768
    s_mov_b32 s63, s27
    s_mov_b32 s64, 7
    s_mov_b32 s65, 2
    s_waitcnt lgkmcnt(0)
    s_add_u32 s42, s42, 0x9e3779b9
    s_addc_u32 s43, s43, 0x7f4a7c15
Lld_w2:
    s_mul_i32 s67, s63, s60
    s_and_b32 s68, s66, 3
    s_lshl_b32 s68, s68, 15
    s_add_u32 s68, s68, s56
    s_mov_b32 m0, s68
    s_add_u32 s67, s67, s59
    buffer_load_dwordx4 v2, s[8:11], s67 offen offset:0 lds
    buffer_load_dwordx4 v3, s[8:11], s67 offen offset:1024 lds
    buffer_load_dwordx4 v4, s[8:11], s67 offen offset:2048 lds
    buffer_load_dwordx4 v5, s[8:11], s67 offen offset:3072 lds
    s_add_u32 s63, s63, s65
    s_sub_u32 s57, s63, s64
    s_cmp_ge_u32 s63, s64
    s_cselect_b32 s63, s57, s63
    s_add_u32 s68, s68, 4096
    s_mov_b32 m0, s68
    s_add_u32 s67, s67, s61
    buffer_load_dwordx4 v2, s[8:11], s67 offen offset:0 lds
    buffer_load_dwordx4 v3, s[8:11], s67 offen offset:1024 lds
    buffer_load_dwordx4 v4, s[8:11], s67 offen offset:2048 lds
    buffer_load_dwordx4 v5, s[8:11], s67 offen offset:3072 lds
    s_add_u32 s66, s66, 1
    s_lshl_b32 s39, s66, 2
    s_add_u32 s68, s68, 4096
    s_mov_b32 m0, s68
    s_add_u32 s67, s67, s61
    buffer_load_dwordx4 v2, s[8:11], s67 offen offset:0 lds
    buffer_load_dwordx4 v3, s[8:11], s67 offen offset:1024 lds
    buffer_load_dwordx4 v4, s[8:11], s67 offen offset:2048 lds
    buffer_load_dwordx4 v5, s[8:11], s67 offen offset:3072 lds
    s_add_u32 s68, s68, 4096
    s_mov_b32 m0, s68
    s_add_u32 s67, s67, s61
    buffer_load_dwordx4 v2, s[8:11], s67 offen offset:0 lds
    buffer_load_dwordx4 v3, s[8:11], s67 offen offset:1024 lds
    buffer_load_dwordx4 v4, s[8:11], s67 offen offset:2048 lds
    buffer_load_dwordx4 v5, s[8:11], s67 offen offset:3072 lds
    s_cmp_lg_u32 s66, 9
    s_cbranch_scc1 Lld_noz
    s_waitcnt vmcnt(16)
    v_cmp_ne_u64 vcc, s[42:43], v[8:9]
    v_cmp_ne_u64 s[52:53], s[42:43], v[10:11]
    s_nop 0
    s_or_b64 vcc, vcc, s[52:53]
    s_cbranch_scc1 Lpa2
Lpd3:
    s_lshr_b32 s68, s56, 3
    s_add_u32 s68, s68, 139264
    s_add_u32 m0, s68, 0
    s_add_u32 s57, s20, 0
    buffer_load_dwordx4 v16, s[12:15], s57 offen sc1 lds
    s_add_u32 m0, s68, 4096
    s_add_u32 s57, s20, 532480
    buffer_load_dwordx4 v16, s[12:15], s57 offen sc1 lds
    s_add_u32 m0, s68, 1024
    s_add_u32 s57, s20, 133120
    buffer_load_dwordx4 v16, s[12:15], s57 offen sc1 lds
    s_add_u32 m0, s68, 5120
    s_add_u32 s57, s20, 665600
    buffer_load_dwordx4 v16, s[12:15], s57 offen sc1 lds
    s_mov_b32 m0, s38
    s_nop 0
    buffer_load_dword v17, s[16:19], 40 offen lds
Lld_noz:
    s_cmp_eq_u32 s66, 12
    s_cbranch_scc1 Lld_done
    s_sub_u32 s39, s66, 3
    s_add_u32 s57, s66, s46
    s_cmp_lg_u32 s57, 16
    s_cbranch_scc1 Lld_nx
    buffer_load_dwordx2 v[12:13], v15, s[12:15], s26 offen sc1
Lls4:
    s_sleep 1
    ds_read_b128 v[20:23], v254 offset:16
    s_waitcnt lgkmcnt(0)
    v_min3_u32 v20, v20, v21, v22
    v_min_u32 v20, v20, v23
    s_nop 0
    v_readfirstlane_b32 s58, v20
    s_add_u32 s55, s55, 1
    s_lshr_b32 s54, s55, 24
    s_lshl_b32 s54, s54, 8
    s_or_b32 s58, s58, s54
    s_cmp_lt_u32 s58, s39
    s_cbranch_scc1 Lls4
    s_waitcnt vmcnt(0)
    v_cmp_ne_u64 vcc, s[42:43], v[12:13]
    s_nop 0
    s_cmp_lg_u64 vcc, 0
    s_cbranch_scc1 Lpa5
Lpd6:
    s_mul_i32 s67, s51, 8320
    s_add_u32 s67, s67, 3407872
    s_mov_b32 m0, 114688
    s_nop 0
    buffer_load_dwordx4 v1, s[12:15], s67 offen offset:0 sc1 lds
    buffer_load_dwordx4 v1, s[12:15], s67 offen offset:1024 sc1 lds
    buffer_load_dwordx4 v1, s[12:15], s67 offen offset:2048 sc1 lds
    buffer_load_dwordx4 v1, s[12:15], s67 offen offset:3072 sc1 lds
    s_add_u32 s67, s67, 4096
    s_mov_b32 m0, 118784
    s_nop 0
    buffer_load_dwordx4 v1, s[12:15], s67 offen offset:0 sc1 lds
    buffer_load_dwordx4 v1, s[12:15], s67 offen offset:1024 sc1 lds
    buffer_load_dwordx4 v1, s[12:15], s67 offen offset:2048 sc1 lds
    buffer_load_dwordx4 v1, s[12:15], s67 offen offset:3072 sc1 lds
    s_branch Lld_done
Lld_nx:
Lls7:
    s_sleep 1
    ds_read_b128 v[20:23], v254 offset:16
    s_waitcnt lgkmcnt(0)
    v_min3_u32 v20, v20, v21, v22
    v_min_u32 v20, v20, v23
    s_nop 0
    v_readfirstlane_b32 s58, v20
    s_add_u32 s55, s55, 1
    s_lshr_b32 s54, s55, 24
    s_lshl_b32 s54, s54, 8
    s_or_b32 s58, s58, s54
    s_cmp_lt_u32 s58, s39
    s_cbranch_scc1 Lls7
    s_branch Lld_w2
Lld_done:
    s_mov_b32 m0, s38
    s_nop 0
    buffer_load_dword v17, s[16:19], 44 offen lds
    s_barrier
    s_barrier
    s_barrier
    s_waitcnt vmcnt(0) lgkmcnt(0)
    s_endpgm
Lhelper_loader:
    v_mov_b64 v[2:3], 0
    v_mov_b64 v[4:5], 0
    s_lshl_b32 s67, s44, 2
    s_and_b32 s57, s45, 3
    s_add_u32 s67, s67, s57
    s_mul_i32 s67, s67, 32896
    s_mov_b32 s10, 1052672
    s_cmp_eq_u32 s46, 5
    s_cselect_b32 s68, 36864, 0
    s_waitcnt lgkmcnt(0)
    s_cselect_b32 s8, s24, s22
    s_cselect_b32 s9, s25, s23
    s_barrier
    s_mov_b32 s69, 9
Lig2:
    s_mov_b32 m0, s68
    s_add_u32 s68, s68, 4096
    buffer_load_dwordx4 v1, s[8:11], s67 offen offset:0 lds
    buffer_load_dwordx4 v1, s[8:11], s67 offen offset:1024 lds
    buffer_load_dwordx4 v1, s[8:11], s67 offen offset:2048 lds
    buffer_load_dwordx4 v1, s[8:11], s67 offen offset:3072 lds
    s_add_u32 s67, s67, 4096
    s_sub_u32 s69, s69, 1
    s_cmp_lg_u32 s69, 5
    s_cbranch_scc1 Lig2b
    s_barrier
    s_barrier
Lig2b:
    s_cmp_lg_u32 s69, 0
    s_cbranch_scc1 Lig2
    s_mov_b32 m0, s38
    s_nop 0
    buffer_load_dword v17, s[16:19], 4 offen lds
    s_branch Lld_ts
Law:
    s_setprio 3
    v_and_b32 v4, 15, v0
    v_lshrrev_b32 v5, 4, v0
    v_lshlrev_b32 v5, 2, v5
    s_lshl_b32 s58, s63, 4
    v_add_u32 v6, s58, v4
    v_cvt_f32_u32 v6, v6
    v_cvt_f32_u32 v32, v5
    v_mul_f32 v6, 0x3b000000, v6
    v_add_f32 v33, 1.0, v32
    v_add_f32 v34, 2.0, v32
    v_add_f32 v35, 1.0, v34
    v_mul_f32 v40, v6, v32
    v_mul_f32 v41, v6, v33
    v_mul_f32 v42, v6, v34
    v_mul_f32 v43, v6, v35
    v_cos_f32 v36, v40
    v_cos_f32 v37, v41
    v_cos_f32 v38, v42
    v_cos_f32 v39, v43
    v_sin_f32 v40, v40
    v_sin_f32 v41, v41
    v_sin_f32 v42, v42
    v_sin_f32 v43, v43
    s_lshl_b32 s58, s63, 11
    s_add_u32 s58, s58, 143360
    v_add_u32 v7, s58, v1
    v_cvt_f32_u32 v4, v4
    v_mul_f32 v4, 0x3d800000, v4
    ds_write_b128 v7, v[36:39]
    ds_write_b128 v7, v[40:43] offset:1024
    v_mul_f32 v48, v4, v32
    v_mul_f32 v49, v4, v33
    v_mul_f32 v50, v4, v34
    v_mul_f32 v51, v4, v35
    v_cos_f32 v52, v48
    v_cos_f32 v53, v49
    v_cos_f32 v54, v50
    v_cos_f32 v55, v51
    v_sin_f32 v48, v48
    v_sin_f32 v49, v49
    v_sin_f32 v50, v50
    v_sin_f32_e64 v51, v51
    v_cvt_pk_bf16_f32 v44, v52, v53
    v_cvt_pk_bf16_f32 v45, v54, v55
    v_cvt_pk_bf16_f32 v46, v48, v49
    v_cvt_pk_bf16_f32 v47, v50, v51
    v_add_u32 v7, 147456, v1
    ds_write_b128 v7, v[44:47]
    s_waitcnt lgkmcnt(0)
    s_load_dwordx2 s[42:43], s[40:41], 0
    s_barrier
    s_mov_b32 s12, s40
    s_mov_b32 s13, s41
    s_lshl_b32 s60, s63, 12
    s_add_u32 s64, s60, 155648
    v_add_u32 v7, s64, v1
    s_mul_i32 s66, s50, 8320
    s_add_u32 s66, s66, s60
    s_add_u32 s66, s66, 1048576
    s_lshl_b32 s60, s63, 11
    s_lshl_b32 s58, s50, 3
    s_add_u32 s60, s60, s58
    s_add_u32 s60, s60, 4096
    v_and_b32 v5, 7, v0
    v_lshl_add_u32 v6, v5, 3, v254
    s_lshl_b32 s67, s50, 7
    s_lshl_b32 s58, s63, 15
    s_add_u32 s67, s67, s58
    s_add_u32 s67, s67, 524288
    s_waitcnt lgkmcnt(0)
    s_add_u32 s42, s42, 0x9e3779b9
    s_addc_u32 s43, s43, 0x7f4a7c15
    v_mov_b32 v74, s42
    v_mov_b32 v75, s43
    s_barrier
    ds_read_b64 v[100:101], v6 offset:64
    ds_read_b128 v[80:83], v7 offset:0
    ds_read_b128 v[84:87], v7 offset:1024
    ds_read_b128 v[88:91], v7 offset:2048
    ds_read_b128 v[92:95], v7 offset:3072
    v_mov_b32 v107, s42
    s_waitcnt lgkmcnt(4)
    v_rcp_f32 v110, v101
    v_mul_f32 v108, v101, v101
    v_cvt_pk_bf16_f32 v105, v100, v110
    v_mul_f32 v109, 0xc0135761, v101
    v_mul_f32 v108, v108, v101
    v_lshlrev_b32 v113, 16, v105
    v_and_b32 v114, s3, v105
    v_sub_f32 v113, v100, v113
    v_sub_f32_e64 v114, v110, v114
    v_mul_f32 v108, 0xbdd2d3e8, v108
    v_cvt_pk_bf16_f32 v104, v100, v113
    v_cvt_pk_bf16_f32 v106, v114, 0
    s_cmp_eq_u32 s63, 0
    s_cselect_b64 vcc, 0, -1
    v_cndmask_b32 v104, v104, v108, vcc
    v_cndmask_b32 v105, v105, v109, vcc
    v_cndmask_b32 v106, v106, v110, vcc
    s_mov_b64 exec, 0xff
    buffer_store_dwordx4 v[104:107], v1, s[12:15], s67 offen sc1
    s_mov_b64 exec, -1
    s_waitcnt lgkmcnt(0)
    buffer_store_dwordx4 v[80:83], v1, s[12:15], s66 offen offset:0 sc1
    buffer_store_dwordx4 v[84:87], v1, s[12:15], s66 offen offset:1024 sc1
    buffer_store_dwordx4 v[88:91], v1, s[12:15], s66 offen offset:2048 sc1
    buffer_store_dwordx4 v[92:95], v1, s[12:15], s66 offen offset:3072 sc1
    s_cmp_eq_u32 s48, 7
    s_cbranch_scc1 Law_nocs
    v_lshrrev_b32 v9, 4, v0
    v_lshlrev_b32_e64 v9, 11, v9
    v_bfe_u32 v5, v0, 2, 2
    v_lshl_add_u32 v9, v5, 6, v9
    v_and_b32 v5, 3, v0
    v_lshl_add_u32 v9, v5, 3, v9
    s_lshl_b32 s58, s63, 9
    s_add_u32 s57, s58, 16384
    v_add_u32 v9, s57, v9
    s_lshl_b32 s68, s62, 14
    s_add_u32 s68, s68, s58
    s_add_u32 s68, s68, 262144
    s_lshl_b32 s58, s47, 10
    s_add_u32 s68, s68, s58
    v_cmp_gt_u32 vcc, 16, v0
    v_mov_b32 v24, 0x3f803f80
    v_mov_b32 v25, 0x3f803f80
    v_mov_b32 v26, 0x3f803f80
    v_mov_b32 v27, 0x3f803f80
Lls8:
    s_sleep 1
    ds_read_b32 v20, v254 offset:512
    s_waitcnt lgkmcnt(0)
    v_readfirstlane_b32 s58, v20
    s_add_u32 s55, s55, 1
    s_lshr_b32 s54, s55, 24
    s_lshl_b32 s54, s54, 8
    s_or_b32 s58, s58, s54
    s_cmp_lt_u32 s58, 1
    s_cbranch_scc1 Lls8
    ds_read_b64_tr_b16 v[128:129], v9 offset:0
    ds_read_b64_tr_b16 v[130:131], v9 offset:1024
    ds_read_b64_tr_b16 v[132:133], v9 offset:32
    ds_read_b64_tr_b16 v[134:135], v9 offset:1056
    ds_read_b64_tr_b16 v[136:137], v9 offset:256
    ds_read_b64_tr_b16 v[138:139], v9 offset:1280
    ds_read_b64_tr_b16 v[140:141], v9 offset:288
    ds_read_b64_tr_b16 v[142:143], v9 offset:1312
    ds_read_b64_tr_b16 v[144:145], v9 offset:8192
    ds_read_b64_tr_b16 v[146:147], v9 offset:9216
    ds_read_b64_tr_b16 v[148:149], v9 offset:8224
    ds_read_b64_tr_b16 v[150:151], v9 offset:9248
    ds_read_b64_tr_b16 v[152:153], v9 offset:8448
    ds_read_b64_tr_b16 v[154:155], v9 offset:9472
    ds_read_b64_tr_b16 v[156:157], v9 offset:8480
    ds_read_b64_tr_b16 v[158:159], v9 offset:9504
    s_waitcnt lgkmcnt(8)
    v_mfma_f32_16x16x32_bf16 v[112:115], v[24:27], v[128:131], 0
    v_mfma_f32_16x16x32_bf16 v[116:119], v[24:27], v[132:135], 0
    v_mfma_f32_16x16x32_bf16 v[120:123], v[24:27], v[136:139], 0
    v_mfma_f32_16x16x32_bf16 v[124:127], v[24:27], v[140:143], 0
    s_waitcnt lgkmcnt(0)
    v_mfma_f32_16x16x32_bf16 v[112:115], v[24:27], v[144:147], v[112:115]
    v_mfma_f32_16x16x32_bf16 v[116:119], v[24:27], v[148:151], v[116:119]
    v_mfma_f32_16x16x32_bf16 v[120:123], v[24:27], v[152:155], v[120:123]
    v_mfma_f32_16x16x32_bf16 v[124:127], v[24:27], v[156:159], v[124:127]
Lls9:
    s_sleep 1
    ds_read_b32 v20, v254 offset:512
    s_waitcnt lgkmcnt(0)
    v_readfirstlane_b32 s58, v20
    s_add_u32 s55, s55, 1
    s_lshr_b32 s54, s55, 24
    s_lshl_b32 s54, s54, 8
    s_or_b32 s58, s58, s54
    s_cmp_lt_u32 s58, 2
    s_cbranch_scc1 Lls9
    ds_read_b64_tr_b16 v[128:129], v9 offset:32768
    ds_read_b64_tr_b16 v[130:131], v9 offset:33792
    ds_read_b64_tr_b16 v[132:133], v9 offset:32800
    ds_read_b64_tr_b16 v[134:135], v9 offset:33824
    ds_read_b64_tr_b16 v[136:137], v9 offset:33024
    ds_read_b64_tr_b16 v[138:139], v9 offset:34048
    ds_read_b64_tr_b16 v[140:141], v9 offset:33056
    ds_read_b64_tr_b16 v[142:143], v9 offset:34080
    ds_read_b64_tr_b16 v[144:145], v9 offset:40960
    ds_read_b64_tr_b16 v[146:147], v9 offset:41984
    ds_read_b64_tr_b16 v[148:149], v9 offset:40992
    ds_read_b64_tr_b16 v[150:151], v9 offset:42016
    ds_read_b64_tr_b16 v[152:153], v9 offset:41216
    ds_read_b64_tr_b16 v[154:155], v9 offset:42240
    ds_read_b64_tr_b16 v[156:157], v9 offset:41248
    ds_read_b64_tr_b16 v[158:159], v9 offset:42272
    s_waitcnt lgkmcnt(8)
    v_mfma_f32_16x16x32_bf16 v[112:115], v[24:27], v[128:131], v[112:115]
    v_mfma_f32_16x16x32_bf16 v[116:119], v[24:27], v[132:135], v[116:119]
    v_mfma_f32_16x16x32_bf16 v[120:123], v[24:27], v[136:139], v[120:123]
    v_mfma_f32_16x16x32_bf16 v[124:127], v[24:27], v[140:143], v[124:127]
    s_waitcnt lgkmcnt(0)
    v_mfma_f32_16x16x32_bf16 v[112:115], v[24:27], v[144:147], v[112:115]
    v_mfma_f32_16x16x32_bf16 v[116:119], v[24:27], v[148:151], v[116:119]
    v_mfma_f32_16x16x32_bf16 v[120:123], v[24:27], v[152:155], v[120:123]
    v_mfma_f32_16x16x32_bf16 v[124:127], v[24:27], v[156:159], v[124:127]
    s_nop 6
    v_cndmask_b32 v72, v120, v112, vcc
    v_cndmask_b32 v73, v124, v116, vcc
    s_mov_b32 exec_hi, 0
    buffer_store_dwordx4 v[72:75], v1, s[12:15], s68 offen sc1
    s_mov_b64 exec, -1
    s_waitcnt vmcnt(1)
    v_mov_b32 v220, s42
    v_mov_b32 v221, s43
    v_mov_b32 v222, 0
    s_mov_b64 exec, 1
    buffer_store_dwordx2 v[220:221], v222, s[12:15], s60 offen sc1
    s_mov_b64 exec, -1
    s_barrier
    s_barrier
    s_branch Law_end
Law_nocs:
    s_waitcnt vmcnt(0)
    v_mov_b32 v220, s42
    v_mov_b32 v221, s43
    v_mov_b32 v222, 0
    s_mov_b64 exec, 1
    buffer_store_dwordx2 v[220:221], v222, s[12:15], s60 offen sc1
    s_mov_b64 exec, -1
Law_end:
    s_endpgm
Lcw:
    s_setprio 2
    s_and_b32 s59, s46, 1
    s_lshl_b32 s59, s59, 4
    s_lshr_b32 s64, s46, 1
    v_and_b32 v132, 15, v0
    v_lshrrev_b32 v133, 4, v0
    v_lshlrev_b32 v133, 2, v133
    s_lshl_b32 s58, s64, 4
    v_add_u32 v6, s58, v132
    v_add_u32 v4, s59, v133
    v_cvt_f32_u32 v6, v6
    v_cvt_f32_u32 v208, v4
    v_mul_f32 v6, 0x3d000000, v6
    v_add_f32 v209, 1.0, v208
    v_add_f32 v210, 2.0, v208
    v_add_f32 v211, 1.0, v210
    v_mul_f32 v220, v6, v208
    v_mul_f32 v221, v6, v209
    v_mul_f32 v222, v6, v210
    v_mul_f32 v223, v6, v211
    v_cos_f32 v224, v220
    v_cos_f32 v225, v221
    v_cos_f32 v226, v222
    v_cos_f32 v227, v223
    v_sin_f32 v220, v220
    v_sin_f32 v221, v221
    v_sin_f32 v222, v222
    v_sin_f32 v223, v223
    v_cvt_pk_bf16_f32 v32, v224, v225
    v_cvt_pk_bf16_f32 v33, v226, v227
    v_cvt_pk_bf16_f32 v34, v220, v221
    v_cvt_pk_bf16_f32 v35, v222, v223
    s_lshl_b32 s58, s46, 10
    s_add_u32 s58, s58, 139264
    v_add_u32 v7, s58, v1
    ds_write_b128 v7, v[32:35]
    s_mov_b32 s56, 0x3f803f80
    s_mov_b32 s18, 2097152
    s_mov_b32 s19, 0x20000
    s_mov_b32 s12, s40
    s_mov_b32 s13, s41
    s_mov_b32 s16, s36
    s_mov_b32 s17, s37
    s_lshl_b32 s58, s46, 2
    v_add_u32 v131, s58, v254
    s_mul_i32 s58, s59, 192
    s_add_u32 s58, s58, 139264
    v_add_u32_e64 v56, s58, v1
    v_xor_b32 v57, 1024, v56
    v_xor_b32 v58, 2048, v56
    v_xor_b32 v59, 3072, v56
    s_lshl_b32 s58, s59, 7
    s_add_u32 s58, s58, 143360
    v_add_u32 v60, s58, v1
    v_xor_b32 v61, 2048, v60
    v_add_u32 v62, 147456, v1
    v_lshlrev_b32 v2, 3, v0
    s_lshl_b32 s58, s59, 5
    s_add_u32 s58, s58, s61
    v_add_u32 v2, s58, v2
    v_xor_b32 v3, 512, v2
    v_mov_b32 v72, 0
    v_mov_b32 v73, 0
    v_mov_b32 v74, 0
    v_mov_b32 v75, 0
    v_bfe_u32 v6, v0, 4, 1
    s_lshl_b32 s58, s46, 4
    s_add_u32 s58, s58, 151616
    v_lshl_add_u32 v246, v6, 3, s58
    v_xor_b32 v5, 16, v4
    v_cvt_f32_u32 v212, v5
    v_add_f32 v213, 1.0, v212
    v_add_f32 v214, 2.0, v212
    v_add_f32 v215, 1.0, v214
    v_add_u32 v4, s59, v132
    v_xor_b32 v5, 16, v4
    v_cvt_f32_u32 v216, v4
    v_cvt_f32_u32 v217, v5
    s_lshl_b32 s57, s46, 3
    s_add_u32 s57, s57, 155648
    v_add_u32 v4, s59, v132
    v_lshl_add_u32 v4, v133, 5, v4
    v_xor_b32 v5, 16, v4
    v_lshrrev_b32 v7, 5, v0
    v_lshlrev_b32 v6, 6, v7
    v_sub_u32 v6, 32, v6
    v_mul_u32_u24 v7, 0x4004, v7
    v_mad_i32_i24 v140, v4, v6, v7
    v_mad_i32_i24 v144, v5, v6, v7
    v_lshlrev_b32_e64 v6, 5, v6
    v_add3_u32 v141, v140, v6, s57
    v_add3_u32 v145, v144, v6, s57
    v_add_u32 v142, v141, v6
    v_add_u32 v143, v142, v6
    v_add_u32 v146, v145, v6
    v_add_u32 v147, v146, v6
    v_and_b32 v140, 0x1fff, v140
    v_and_b32 v144, 0x1fff, v144
    v_add_u32 v140, s57, v140
    v_add_u32 v144, s57, v144
    s_waitcnt vmcnt(0) lgkmcnt(0)
    ds_read_b64_tr_b16 v[64:65], v2
    ds_read_b64_tr_b16 v[66:67], v2 offset:1024
    ds_read_b64_tr_b16 v[68:69], v3
    ds_read_b64_tr_b16 v[70:71], v3 offset:1024
    s_barrier
    ds_read_b128 v[10:13], v56
    ds_read_b128 v[16:19], v57
    ds_read_b128 v[22:25], v58
    ds_read_b128 v[28:31], v59
    ds_read_b128 v[40:43], v60
    ds_read_b128 v[48:51], v60 offset:1024
    ds_read_b128 v[44:47], v61
    ds_read_b128 v[52:55], v61 offset:1024
    ds_read_b128 v[34:37], v62
    s_waitcnt lgkmcnt(9)
    v_dot2c_f32_bf16 v72, s56, v64
    v_dot2c_f32_bf16 v74, v64, v64
    v_dot2c_f32_bf16 v73, s56, v66
    v_dot2c_f32_bf16 v75, v66, v66
    v_dot2c_f32_bf16 v72, s56, v65
    v_dot2c_f32_bf16 v74, v65, v65
    v_dot2c_f32_bf16 v73, s56, v67
    v_dot2c_f32_bf16 v75, v67, v67
    v_dot2c_f32_bf16 v72, s56, v68
    v_dot2c_f32_bf16 v74, v68, v68
    v_dot2c_f32_bf16 v73, s56, v70
    v_dot2c_f32_bf16 v75, v70, v70
    v_dot2c_f32_bf16 v72, s56, v69
    v_dot2c_f32_bf16 v74, v69, v69
    v_dot2c_f32_bf16 v73, s56, v71
    v_dot2c_f32_bf16 v75, v71, v71
    v_lshlrev_b32 v80, 16, v64
    v_and_b32 v81, s3, v64
    v_lshlrev_b32 v82, 16, v65
    v_permlane16_swap_b32 v72, v73
    v_permlane16_swap_b32 v74, v75
    v_add_f32 v72, v72, v73
    v_add_f32 v74, v74, v75
    v_mov_b32 v73, v72
    v_mov_b32 v75, v74
    v_and_b32 v83, s3, v65
    v_permlane32_swap_b32 v72, v73
    v_permlane32_swap_b32 v74, v75
    v_add_f32 v72, v72, v73
    v_add_f32 v74, v74, v75
    v_lshlrev_b32 v84, 16, v66
    v_add_f32_dpp v72, v72, v72 row_ror:8 row_mask:0xf bank_mask:0xf
    v_add_f32_dpp v74, v74, v74 row_ror:8 row_mask:0xf bank_mask:0xf
    v_and_b32_e64 v85, s3, v66
    v_add_f32_dpp v72, v72, v72 row_ror:4 row_mask:0xf bank_mask:0xf
    v_add_f32_dpp v74, v74, v74 row_ror:4 row_mask:0xf bank_mask:0xf
    v_lshlrev_b32_e64 v86, 16, v67
    v_add_f32_dpp v72, v72, v72 row_ror:2 row_mask:0xf bank_mask:0xf
    v_add_f32_dpp v74, v74, v74 row_ror:2 row_mask:0xf bank_mask:0xf
    v_and_b32_e64 v87, s3, v67
    v_add_f32_dpp v72, v72, v72 row_ror:1 row_mask:0xf bank_mask:0xf
    v_add_f32_dpp v74, v74, v74 row_ror:1 row_mask:0xf bank_mask:0xf
    v_mul_f32 v244, 0xbb000000, v72
    v_mul_f32 v74, 0x3b000000, v74
    v_fma_f32 v74, -v244, v244, v74
    v_max_f32_e64 v74, 0, v74
    v_add_f32 v73, 0x3727c5ac, v74
    v_mov_b32 v72, 0x2edbe6ff
    v_rsq_f32 v73, v73
    v_fmac_f32 v72, 0x3f800054, v74
    v_rsq_f32 v245, v72
    v_mul_f32 v75, v244, v73
    v_lshlrev_b32 v88, 16, v68
    v_and_b32_e64 v89, s3, v68
    v_readlane_b32 s20, v73, 0
    v_readlane_b32 s21, v75, 0
    v_readlane_b32 s22, v73, 16
    v_readlane_b32 s23, v75, 16
    v_lshlrev_b32 v90, 16, v69
    v_and_b32 v91, s3, v69
    v_lshlrev_b32 v92, 16, v70
    v_and_b32 v93, s3, v70
    v_lshlrev_b32 v94, 16, v71
    v_and_b32 v95, s3, v71
    s_waitcnt lgkmcnt(0)
    s_mov_b32 s58, 0x80008000
    v_xor_b32 v8, s58, v12
    v_xor_b32 v9, s58, v13
    v_xor_b32 v14, s58, v18
    v_xor_b32 v15, s58, v19
    v_xor_b32 v20, s58, v24
    v_xor_b32 v21, s58, v25
    v_xor_b32 v26, s58, v30
    v_xor_b32 v27, s58, v31
    v_xor_b32 v32, s58, v36
    v_xor_b32_e64 v33, s58, v37
    s_load_dwordx2 s[42:43], s[40:41], 0
    v_pk_fma_f32 v[80:81], v[80:81], s[20:21], s[20:21] op_sel:[0,0,1] op_sel_hi:[1,0,1]
    v_pk_fma_f32 v[82:83], v[82:83], s[20:21], s[20:21] op_sel:[0,0,1] op_sel_hi:[1,0,1]
    v_pk_fma_f32 v[84:85], v[84:85], s[22:23], s[22:23] op_sel:[0,0,1] op_sel_hi:[1,0,1]
    v_pk_fma_f32 v[86:87], v[86:87], s[22:23], s[22:23] op_sel:[0,0,1] op_sel_hi:[1,0,1]
    v_pk_fma_f32 v[88:89], v[88:89], s[20:21], s[20:21] op_sel:[0,0,1] op_sel_hi:[1,0,1]
    v_pk_fma_f32 v[90:91], v[90:91], s[20:21], s[20:21] op_sel:[0,0,1] op_sel_hi:[1,0,1]
    v_pk_fma_f32 v[92:93], v[92:93], s[22:23], s[22:23] op_sel:[0,0,1] op_sel_hi:[1,0,1]
    v_pk_fma_f32 v[94:95], v[94:95], s[22:23], s[22:23] op_sel:[0,0,1] op_sel_hi:[1,0,1]
    v_cvt_pk_bf16_f32 v64, v80, v81
    v_cvt_pk_bf16_f32 v65, v82, v83
    v_cvt_pk_bf16_f32 v66, v84, v85
    v_cvt_pk_bf16_f32 v67, v86, v87
    v_cvt_pk_bf16_f32 v68, v88, v89
    v_cvt_pk_bf16_f32 v69, v90, v91
    v_cvt_pk_bf16_f32 v70, v92, v93
    v_cvt_pk_bf16_f32 v71, v94, v95
    v_mfma_f32_16x16x32_bf16 v[96:99], v[64:67], v[10:13], 0
    v_mfma_f32_16x16x32_bf16 v[100:103], v[64:67], v[8:11], 0
    v_mfma_f32_16x16x32_bf16 v[96:99], v[68:71], v[16:19], v[96:99]
    v_mfma_f32_16x16x32_bf16 v[100:103], v[68:71], v[14:17], v[100:103]
    v_mfma_f32_16x16x32_bf16 v[104:107], v[64:67], v[22:25], 0
    v_mfma_f32_16x16x32_bf16 v[108:111], v[64:67], v[20:23], 0
    v_mfma_f32_16x16x32_bf16 v[104:107], v[68:71], v[28:31], v[104:107]
    v_mfma_f32_16x16x32_bf16 v[108:111], v[68:71], v[26:29], v[108:111]
    v_mul_f32 v6, 0x3a800000, v216
    v_mul_f32 v195, 0x3a800000, v217
    s_nop 1
    s_nop 0
    v_pk_mul_f32 v[80:81], v[100:101], v[48:49]
    v_pk_mul_f32 v[84:85], v[96:97], v[48:49]
    v_pk_mul_f32 v[82:83], v[102:103], v[50:51]
    v_pk_mul_f32 v[86:87], v[98:99], v[50:51]
    v_pk_fma_f32 v[80:81], v[96:97], v[40:41], v[80:81]
    v_pk_fma_f32 v[84:85], v[100:101], v[40:41], v[84:85] neg_lo:[0,0,1] neg_hi:[0,0,1]
    v_pk_fma_f32 v[82:83], v[98:99], v[42:43], v[82:83]
    v_pk_fma_f32 v[86:87], v[102:103], v[42:43], v[86:87] neg_lo:[0,0,1] neg_hi:[0,0,1]
    v_cvt_pk_bf16_f32 v64, v80, v81
    v_cvt_pk_bf16_f32 v65, v82, v83
    v_cvt_pk_bf16_f32 v66, v84, v85
    v_cvt_pk_bf16_f32 v67, v86, v87
    v_pk_mul_f32 v[88:89], v[108:109], v[52:53]
    v_pk_mul_f32 v[92:93], v[104:105], v[52:53]
    v_pk_mul_f32 v[90:91], v[110:111], v[54:55]
    v_pk_mul_f32 v[94:95], v[106:107], v[54:55]
    v_pk_fma_f32 v[88:89], v[104:105], v[44:45], v[88:89]
    v_pk_fma_f32 v[92:93], v[108:109], v[44:45], v[92:93] neg_lo:[0,0,1] neg_hi:[0,0,1]
    v_pk_fma_f32 v[90:91], v[106:107], v[46:47], v[90:91]
    v_pk_fma_f32 v[94:95], v[110:111], v[46:47], v[94:95] neg_lo:[0,0,1] neg_hi:[0,0,1]
    v_cvt_pk_bf16_f32 v68, v88, v89
    v_cvt_pk_bf16_f32 v69, v90, v91
    v_cvt_pk_bf16_f32 v70, v92, v93
    v_cvt_pk_bf16_f32 v71, v94, v95
    v_mfma_f32_16x16x32_bf16 v[112:115], v[34:37], v[64:67], 0
    v_mfma_f32_16x16x32_bf16 v[116:119], v[32:35], v[64:67], 0
    v_mfma_f32_16x16x32_bf16 v[120:123], v[34:37], v[68:71], 0
    v_mfma_f32_16x16x32_bf16 v[124:127], v[32:35], v[68:71], 0
    v_mul_f32 v160, v6, v208
    v_mul_f32 v161, v6, v209
    v_mul_f32 v162, v6, v210
    v_mul_f32 v163, v6, v211
    v_mul_f32 v164, v6, v212
    v_mul_f32 v165, v6, v213
    v_mul_f32 v166, v6, v214
    v_mul_f32 v167, v6, v215
    v_cvt_pk_bf16_f32 v236, v112, v116
    v_cvt_pk_bf16_f32 v237, v113, v117
    v_cvt_pk_bf16_f32 v238, v114, v118
    v_cvt_pk_bf16_f32 v239, v115, v119
    v_cvt_pk_bf16_f32 v240, v120, v124
    v_cvt_pk_bf16_f32 v241, v121, v125
    v_cvt_pk_bf16_f32 v242, v122, v126
    v_cvt_pk_bf16_f32 v243, v123, v127
    v_readlane_b32 s20, v236, 32
    v_readlane_b32 s21, v240, 32
    v_readlane_b32 s22, v236, 0
    v_readlane_b32 s23, v240, 0
    v_mov_b32 v247, 2
    s_cmp_eq_u32 s59, 0
    s_cselect_b32 s20, s20, s22
    s_cselect_b32 s21, s23, s21
    v_writelane_b32 v236, s20, 0
    v_writelane_b32 v240, s21, 0
    ds_write_b64 v246, v[244:245]
    ds_write_b32 v140, v236
    ds_write_b32 v141, v237
    ds_write_b32 v142, v238
    ds_write_b32 v143, v239
    ds_write_b32 v144, v240
    ds_write_b32 v145, v241
    ds_write_b32 v146, v242
    ds_write_b32 v147, v243
    s_cmp_eq_u32 s48, 7
    s_cbranch_scc1 Lhelper
    v_and_b32 v7, 31, v0
    v_lshrrev_b32 v2, 5, v0
    v_bfe_u32 v3, v0, 1, 3
    v_xor_b32 v2, v2, v3
    v_lshlrev_b32 v2, 4, v2
    v_lshl_add_u32 v2, v7, 7, v2
    s_lshl_b32 s58, s64, 13
    v_add_u32 v2, s58, v2
    v_xor_b32 v3, 32, v2
    v_xor_b32 v4, 64, v2
    v_xor_b32 v5, 96, v2
    v_lshrrev_b32 v6, 5, v0
    v_lshlrev_b32 v6, 11, v6
    v_bfe_u32 v7, v0, 2, 2
    v_lshl_add_u32 v6, v7, 6, v6
    v_bfe_u32 v7, v0, 4, 1
    v_lshl_add_u32 v6, v7, 5, v6
    v_and_b32 v7, 3, v0
    v_lshl_add_u32 v6, v7, 3, v6
    s_lshl_b32 s58, s59, 5
    s_add_u32 s58, s58, 16384
    v_add_u32 v6, s58, v6
    s_mov_b32 s69, 0x10000
    s_waitcnt lgkmcnt(0)
    s_barrier
    s_add_u32 s42, s42, 0x9e3779b9
    s_addc_u32 s43, s43, 0x7f4a7c15
Lls10:
    ds_read2_b32 v[138:139], v254 offset0:64 offset1:128
    s_waitcnt lgkmcnt(0)
    v_min_u32 v138, v138, v139
    s_nop 0
    v_readfirstlane_b32 s58, v138
    s_add_u32 s55, s55, 1
    s_lshr_b32 s54, s55, 24
    s_lshl_b32 s54, s54, 8
    s_or_b32 s58, s58, s54
    s_cmp_lt_u32 s58, 1
    s_cbranch_scc1 Lls10
    ds_read_b64_tr_b16 v[32:33], v6 offset:0
    ds_read_b64_tr_b16 v[34:35], v6 offset:1024
    ds_read_b128 v[40:43], v2 offset:0
    ds_read_b128 v[44:47], v2 offset:4096
    ds_read_b64_tr_b16 v[36:37], v6 offset:256
    ds_read_b64_tr_b16 v[38:39], v6 offset:1280
    ds_read_b64_tr_b16 v[48:49], v6 offset:4096
    ds_read_b64_tr_b16 v[50:51], v6 offset:5120
    ds_read_b128 v[56:59], v3 offset:0
    ds_read_b128 v[60:63], v3 offset:4096
    ds_read_b64_tr_b16 v[52:53], v6 offset:4352
    ds_read_b64_tr_b16 v[54:55], v6 offset:5376
    s_waitcnt lgkmcnt(6)
    v_mfma_f32_32x32x16_bf16 v[64:79], v[32:35], v[40:43], 0
    v_and_b32 v134, 31, v0
    v_lshlrev_b32 v134, 4, v134
    s_lshl_b32 s53, s64, 10
    v_mfma_f32_32x32x16_bf16 v[80:95], v[32:35], v[44:47], 0
    ds_read_b64_tr_b16 v[32:33], v6 offset:8192
    ds_read_b64_tr_b16 v[34:35], v6 offset:9216
    s_add_u32 s53, s53, 155648
    v_add_u32 v135, s53, v1
    v_mfma_f32_32x32x16_bf16 v[96:111], v[36:39], v[40:43], 0
    ds_read_b128 v[40:43], v4 offset:0
    v_add_u32 v134, s53, v134
    v_lshrrev_b32 v136, 5, v0
    v_and_b32 v199, 15, v0
    v_mfma_f32_32x32x16_bf16 v[112:127], v[36:39], v[44:47], 0
    ds_read_b128 v[44:47], v4 offset:4096
    ds_read_b64_tr_b16 v[36:37], v6 offset:8448
    ds_read_b64_tr_b16 v[38:39], v6 offset:9472
    v_lshl_add_u32 v136, v136, 4, v199
    s_waitcnt lgkmcnt(6)
    v_mfma_f32_32x32x16_bf16 v[64:79], v[48:51], v[56:59], v[64:79]
    ds_read2_b32 v[138:139], v254 offset0:64 offset1:128
    v_lshlrev_b32 v199, 4, v136
    s_lshl_b32 s52, s59, 5
    s_add_u32 s52, s52, 159744
    v_mfma_f32_32x32x16_bf16 v[80:95], v[48:51], v[60:63], v[80:95]
    ds_read_b64_tr_b16 v[48:49], v6 offset:12288
    ds_read_b64_tr_b16 v[50:51], v6 offset:13312
    v_add_u32 v136, s52, v199
    s_lshl_b32 s67, s47, 2
    v_mfma_f32_32x32x16_bf16 v[96:111], v[52:55], v[56:59], v[96:111]
    ds_read_b128 v[56:59], v5 offset:0
    s_and_b32 s53, s46, 2
    s_add_u32 s67, s67, s53
    s_lshl_b32 s52, s62, 13
    v_mfma_f32_32x32x16_bf16 v[112:127], v[52:55], v[60:63], v[112:127]
    ds_read_b128 v[60:63], v5 offset:4096
    ds_read_b64_tr_b16 v[52:53], v6 offset:12544
    ds_read_b64_tr_b16 v[54:55], v6 offset:13568
    s_lshl_b32 s53, s59, 8
    s_waitcnt lgkmcnt(6)
    v_mfma_f32_32x32x16_bf16 v[64:79], v[32:35], v[40:43], v[64:79]
    v_min_u32 v138, v138, v139
    v_mov_b32 v137, 1
    v_readfirstlane_b32 s58, v138
    s_nop 0
    s_cmp_lt_u32 s58, 2
    s_cbranch_scc1 Lcs11
Lcb12:
    v_mfma_f32_32x32x16_bf16 v[80:95], v[32:35], v[44:47], v[80:95]
    ds_read_b64_tr_b16 v[32:33], v6 offset:32768
    ds_read_b64_tr_b16 v[34:35], v6 offset:33792
    s_add_u32 s52, s52, s53
    s_add_u32 s52, s52, 8388608
    v_mfma_f32_32x32x16_bf16 v[96:111], v[36:39], v[40:43], v[96:111]
    ds_read_b128 v[40:43], v2 offset:32768
    s_mul_i32 s67, s67, 114688
    s_add_u32 s67, s67, s52
    s_add_u32 s68, s67, 114688
    v_mfma_f32_32x32x16_bf16 v[112:127], v[36:39], v[44:47], v[112:127]
    ds_read_b128 v[44:47], v2 offset:36864
    ds_read_b64_tr_b16 v[36:37], v6 offset:33024
    ds_read_b64_tr_b16 v[38:39], v6 offset:34048
    v_cos_f32 v152, v160
    s_waitcnt lgkmcnt(6)
    v_mfma_f32_32x32x16_bf16 v[64:79], v[48:51], v[56:59], v[64:79]
    v_cos_f32 v153, v161
    v_cos_f32 v154, v162
    v_cos_f32 v155, v163
    v_mfma_f32_32x32x16_bf16 v[80:95], v[48:51], v[60:63], v[80:95]
    ds_read_b64_tr_b16 v[48:49], v6 offset:36864
    ds_read_b64_tr_b16 v[50:51], v6 offset:37888
    v_cos_f32 v156, v164
    v_cos_f32 v157, v165
    v_mfma_f32_32x32x16_bf16 v[96:111], v[52:55], v[56:59], v[96:111]
    ds_read_b128 v[56:59], v3 offset:32768
    v_cos_f32 v158, v166
    v_cos_f32 v159, v167
    v_sin_f32 v160, v160
    v_mfma_f32_32x32x16_bf16 v[112:127], v[52:55], v[60:63], v[112:127]
    ds_read_b128 v[60:63], v3 offset:36864
    ds_read_b64_tr_b16 v[52:53], v6 offset:37120
    ds_read_b64_tr_b16 v[54:55], v6 offset:38144
    v_sin_f32 v161, v161
    s_waitcnt lgkmcnt(6)
    v_mfma_f32_32x32x16_bf16 v[64:79], v[32:35], v[40:43], v[64:79]
    v_sin_f32 v162, v162
    v_sin_f32 v163, v163
    v_sin_f32 v164, v164
    v_mfma_f32_32x32x16_bf16 v[80:95], v[32:35], v[44:47], v[80:95]
    ds_read_b64_tr_b16 v[32:33], v6 offset:40960
    ds_read_b64_tr_b16 v[34:35], v6 offset:41984
    v_sin_f32 v165, v165
    v_sin_f32 v166, v166
    v_mfma_f32_32x32x16_bf16 v[96:111], v[36:39], v[40:43], v[96:111]
    ds_read_b128 v[40:43], v4 offset:32768
    v_sin_f32 v167, v167
    v_mul_f32 v172, v195, v208
    v_mul_f32 v173, v195, v209
    v_mfma_f32_32x32x16_bf16 v[112:127], v[36:39], v[44:47], v[112:127]
    ds_read_b128 v[44:47], v4 offset:36864
    ds_read_b64_tr_b16 v[36:37], v6 offset:41216
    ds_read_b64_tr_b16 v[38:39], v6 offset:42240
    v_mul_f32 v174, v195, v210
    s_waitcnt lgkmcnt(6)
    v_mfma_f32_32x32x16_bf16 v[64:79], v[48:51], v[56:59], v[64:79]
    ds_read2_b32 v[138:139], v254 offset0:64 offset1:128
    v_mul_f32 v175, v195, v211
    v_cos_f32 v168, v172
    v_cos_f32 v169, v173
    v_mfma_f32_32x32x16_bf16 v[80:95], v[48:51], v[60:63], v[80:95]
    ds_read_b64_tr_b16 v[48:49], v6 offset:45056
    ds_read_b64_tr_b16 v[50:51], v6 offset:46080
    v_cos_f32 v170, v174
    v_cos_f32 v171, v175
    v_mfma_f32_32x32x16_bf16 v[96:111], v[52:55], v[56:59], v[96:111]
    ds_read_b128 v[56:59], v5 offset:32768
    v_sin_f32 v172, v172
    v_sin_f32 v173, v173
    v_sin_f32 v174, v174
    v_mfma_f32_32x32x16_bf16 v[112:127], v[52:55], v[60:63], v[112:127]
    ds_read_b128 v[60:63], v5 offset:36864
    ds_read_b64_tr_b16 v[52:53], v6 offset:45312
    ds_read_b64_tr_b16 v[54:55], v6 offset:46336
    v_sin_f32 v175, v175
    s_waitcnt lgkmcnt(6)
    v_mfma_f32_32x32x16_bf16 v[64:79], v[32:35], v[40:43], v[64:79]
    v_min_u32 v138, v138, v139
    s_nop 0
    v_readfirstlane_b32 s58, v138
    v_xor_b32 v2, s69, v2
    v_xor_b32 v3, s69, v3
    v_xor_b32 v4, s69, v4
    v_xor_b32 v5, s69, v5
    v_xor_b32 v6, s69, v6
    s_cmp_lt_u32 s58, 3
    s_cbranch_scc1 Lcs13
Lcb14:
    v_mfma_f32_32x32x16_bf16 v[80:95], v[32:35], v[44:47], v[80:95]
    ds_read_b64_tr_b16 v[32:33], v6 offset:0
    ds_read_b64_tr_b16 v[34:35], v6 offset:1024
    v_lshrrev_b32 v192, 5, v0
    v_lshlrev_b32 v192, 7, v192
    v_mfma_f32_32x32x16_bf16 v[96:111], v[36:39], v[40:43], v[96:111]
    ds_read_b128 v[40:43], v2 offset:0
    v_bfe_u32 v193, v0, 1, 4
    v_add_u32 v192, v192, v193
    v_and_b32 v193, 1, v0
    v_mfma_f32_32x32x16_bf16 v[112:127], v[36:39], v[44:47], v[112:127]
    ds_read_b128 v[44:47], v2 offset:4096
    ds_read_b64_tr_b16 v[36:37], v6 offset:256
    ds_read_b64_tr_b16 v[38:39], v6 offset:1280
    v_lshl_add_u32 v192, v193, 6, v192
    s_waitcnt lgkmcnt(6)
    v_mfma_f32_32x32x16_bf16 v[64:79], v[48:51], v[56:59], v[64:79]
    s_barrier
    s_lshl_b32 s53, s64, 9
    s_add_u32 s53, s53, s59
    v_add_u32 v192, s53, v192
    v_mfma_f32_32x32x16_bf16 v[80:95], v[48:51], v[60:63], v[80:95]
    ds_read_b64_tr_b16 v[48:49], v6 offset:4096
    ds_read_b64_tr_b16 v[50:51], v6 offset:5120
    v_cvt_f32_u32_e64 v192, v192
    v_mul_f32 v220, 0x3a000000, v192
    v_mfma_f32_32x32x16_bf16 v[96:111], v[52:55], v[56:59], v[96:111]
    ds_read_b128 v[56:59], v3 offset:0
    v_add_f32 v221, 0x3c800000, v220
    v_add_f32 v222, 0x3e000000, v220
    v_add_f32 v223, 0x3e100000, v220
    v_mfma_f32_32x32x16_bf16 v[112:127], v[52:55], v[60:63], v[112:127]
    ds_read_b128 v[60:63], v3 offset:4096
    ds_read_b64_tr_b16 v[52:53], v6 offset:4352
    ds_read_b64_tr_b16 v[54:55], v6 offset:5376
    v_cos_f32 v224, v220
    s_waitcnt lgkmcnt(6)
    v_mfma_f32_32x32x16_bf16 v[64:79], v[32:35], v[40:43], v[64:79]
    v_cos_f32 v225, v221
    v_cos_f32 v226, v222
    v_cos_f32 v227, v223
    v_mfma_f32_32x32x16_bf16 v[80:95], v[32:35], v[44:47], v[80:95]
    ds_read_b64_tr_b16 v[32:33], v6 offset:8192
    ds_read_b64_tr_b16 v[34:35], v6 offset:9216
    v_sin_f32 v220, v220
    v_sin_f32 v221, v221
    v_mfma_f32_32x32x16_bf16 v[96:111], v[36:39], v[40:43], v[96:111]
    ds_read_b128 v[40:43], v4 offset:0
    v_sin_f32 v222, v222
    v_sin_f32 v223, v223
    v_add_f32 v228, v224, v220
    v_mfma_f32_32x32x16_bf16 v[112:127], v[36:39], v[44:47], v[112:127]
    ds_read_b128 v[44:47], v4 offset:4096
    ds_read_b64_tr_b16 v[36:37], v6 offset:8448
    ds_read_b64_tr_b16 v[38:39], v6 offset:9472
    v_add_f32 v229, v225, v221
    s_waitcnt lgkmcnt(6)
    v_mfma_f32_32x32x16_bf16 v[64:79], v[48:51], v[56:59], v[64:79]
    ds_read2_b32 v[138:139], v254 offset0:64 offset1:128
    v_add_f32 v230, v226, v222
    v_add_f32 v231, v227, v223
    v_sub_f32 v220, v224, v220
    v_mfma_f32_32x32x16_bf16 v[80:95], v[48:51], v[60:63], v[80:95]
    ds_read_b64_tr_b16 v[48:49], v6 offset:12288
    ds_read_b64_tr_b16 v[50:51], v6 offset:13312
    v_sub_f32 v221, v225, v221
    v_sub_f32 v222, v226, v222
    v_mfma_f32_32x32x16_bf16 v[96:111], v[52:55], v[56:59], v[96:111]
    ds_read_b128 v[56:59], v5 offset:0
    v_sub_f32 v223, v227, v223
    v_cvt_pk_bf16_f32 v176, v228, v220
    v_cvt_pk_bf16_f32 v180, v220, v228
    v_mfma_f32_32x32x16_bf16 v[112:127], v[52:55], v[60:63], v[112:127]
    ds_read_b128 v[60:63], v5 offset:4096
    ds_read_b64_tr_b16 v[52:53], v6 offset:12544
    ds_read_b64_tr_b16 v[54:55], v6 offset:13568
    v_cvt_pk_bf16_f32 v177, v229, v221
    s_waitcnt lgkmcnt(6)
    v_mfma_f32_32x32x16_bf16 v[64:79], v[32:35], v[40:43], v[64:79]
    v_min_u32 v138, v138, v139
    s_nop 0
    v_readfirstlane_b32 s58, v138
    s_nop 0
    s_cmp_lt_u32 s58, 4
    s_cbranch_scc1 Lcs15
Lcb16:
    v_mfma_f32_32x32x16_bf16 v[80:95], v[32:35], v[44:47], v[80:95]
    ds_read_b64_tr_b16 v[32:33], v6 offset:32768
    ds_read_b64_tr_b16 v[34:35], v6 offset:33792
    v_cvt_pk_bf16_f32 v181, v221, v229
    v_cvt_pk_bf16_f32 v178, v230, v222
    v_mfma_f32_32x32x16_bf16 v[96:111], v[36:39], v[40:43], v[96:111]
    ds_read_b128 v[40:43], v2 offset:32768
    v_cvt_pk_bf16_f32 v182, v222, v230
    v_cvt_pk_bf16_f32 v179, v231, v223
    v_cvt_pk_bf16_f32 v183, v223, v231
    v_mfma_f32_32x32x16_bf16 v[112:127], v[36:39], v[44:47], v[112:127]
    ds_read_b128 v[44:47], v2 offset:36864
    ds_read_b64_tr_b16 v[36:37], v6 offset:33024
    ds_read_b64_tr_b16 v[38:39], v6 offset:34048
    v_lshrrev_b32 v193, 5, v0
    s_waitcnt lgkmcnt(6)
    v_mfma_f32_32x32x16_bf16 v[64:79], v[48:51], v[56:59], v[64:79]
    s_barrier
    v_lshlrev_b32 v193, 5, v193
    v_bfe_u32 v194, v0, 1, 4
    v_add_u32 v193, v193, v194
    v_mfma_f32_32x32x16_bf16 v[80:95], v[48:51], v[60:63], v[80:95]
    ds_read_b64_tr_b16 v[48:49], v6 offset:36864
    ds_read_b64_tr_b16 v[50:51], v6 offset:37888
    v_lshlrev_b32 v130, 5, v193
    v_and_b32 v194, 1, v0
    v_mfma_f32_32x32x16_bf16 v[96:111], v[52:55], v[56:59], v[96:111]
    ds_read_b128 v[56:59], v3 offset:32768
    v_lshl_add_u32 v130, v194, 4, v130
    v_lshrrev_b32 v193, 1, v0
    v_lshlrev_b32 v193, 4, v193
    v_mfma_f32_32x32x16_bf16 v[112:127], v[52:55], v[60:63], v[112:127]
    ds_read_b128 v[60:63], v3 offset:36864
    ds_read_b64_tr_b16 v[52:53], v6 offset:37120
    ds_read_b64_tr_b16 v[54:55], v6 offset:38144
    v_lshl_add_u32 v190, v194, 3, v193
    s_waitcnt lgkmcnt(6)
    v_mfma_f32_32x32x16_bf16 v[64:79], v[32:35], v[40:43], v[64:79]
    s_lshl_b32 s53, s46, 10
    s_add_u32 s52, s53, 139264
    v_add_u32 v190, s52, v190
    v_mfma_f32_32x32x16_bf16 v[80:95], v[32:35], v[44:47], v[80:95]
    ds_read_b64_tr_b16 v[32:33], v6 offset:40960
    ds_read_b64_tr_b16 v[34:35], v6 offset:41984
    s_add_u32 s52, s53, 147456
    v_add_u32 v188, s52, v1
    v_mfma_f32_32x32x16_bf16 v[96:111], v[36:39], v[40:43], v[96:111]
    ds_read_b128 v[40:43], v4 offset:32768
    v_xor_b32 v189, 1024, v188
    s_lshl_b32 s53, s64, 12
    s_mul_i32 s52, s59, 192
    v_mfma_f32_32x32x16_bf16 v[112:127], v[36:39], v[44:47], v[112:127]
    ds_read_b128 v[44:47], v4 offset:36864
    ds_read_b64_tr_b16 v[36:37], v6 offset:41216
    ds_read_b64_tr_b16 v[38:39], v6 offset:42240
    s_add_u32 s52, s53, s52
    s_waitcnt lgkmcnt(6)
    v_mfma_f32_32x32x16_bf16 v[64:79], v[48:51], v[56:59], v[64:79]
    ds_read2_b32 v[138:139], v254 offset0:64 offset1:128
    s_add_u32 s52, s52, 139264
    v_add_u32 v184, s52, v1
    v_xor_b32 v185, 1024, v184
    v_mfma_f32_32x32x16_bf16 v[80:95], v[48:51], v[60:63], v[80:95]
    ds_read_b64_tr_b16 v[48:49], v6 offset:45056
    ds_read_b64_tr_b16 v[50:51], v6 offset:46080
    v_xor_b32 v186, 2048, v184
    v_xor_b32 v187, 3072, v184
    v_mfma_f32_32x32x16_bf16 v[96:111], v[52:55], v[56:59], v[96:111]
    ds_read_b128 v[56:59], v5 offset:32768
    v_lshl_add_u32 v196, v194, 2, v193
    s_lshl_b32 s53, s46, 10
    s_add_u32 s52, s53, 139264
    v_mfma_f32_32x32x16_bf16 v[112:127], v[52:55], v[60:63], v[112:127]
    ds_read_b128 v[60:63], v5 offset:36864
    ds_read_b64_tr_b16 v[52:53], v6 offset:45312
    ds_read_b64_tr_b16 v[54:55], v6 offset:46336
    v_add_u32 v196, s52, v196
    s_waitcnt lgkmcnt(6)
    v_mfma_f32_32x32x16_bf16 v[64:79], v[32:35], v[40:43], v[64:79]
    v_min_u32 v138, v138, v139
    s_nop 0
    v_readfirstlane_b32 s58, v138
    v_xor_b32 v2, s69, v2
    v_xor_b32 v3, s69, v3
    v_xor_b32 v4, s69, v4
    v_xor_b32 v5, s69, v5
    v_xor_b32 v6, s69, v6
    s_cmp_lt_u32 s58, 5
    s_cbranch_scc1 Lcs17
Lcb18:
    v_mfma_f32_32x32x16_bf16 v[80:95], v[32:35], v[44:47], v[80:95]
    ds_read_b64_tr_b16 v[32:33], v6 offset:0
    ds_read_b64_tr_b16 v[34:35], v6 offset:1024
    v_add_u32 v197, 4096, v196
    v_add_u32 v128, s52, v1
    v_mfma_f32_32x32x16_bf16 v[96:111], v[36:39], v[40:43], v[96:111]
    ds_read_b128 v[40:43], v2 offset:0
    v_lshlrev_b32 v194, 8, v133
    v_lshl_add_u32 v129, v132, 2, v194
    s_lshl_b32 s52, s59, 8
    v_mfma_f32_32x32x16_bf16 v[112:127], v[36:39], v[44:47], v[112:127]
    ds_read_b128 v[44:47], v2 offset:4096
    ds_read_b64_tr_b16 v[36:37], v6 offset:256
    ds_read_b64_tr_b16 v[38:39], v6 offset:1280
    s_lshl_b32 s53, s46, 6
    s_waitcnt lgkmcnt(6)
    v_mfma_f32_32x32x16_bf16 v[64:79], v[48:51], v[56:59], v[64:79]
    s_barrier
    s_add_u32 s53, s53, s52
    s_add_u32 s53, s53, 114688
    v_add_u32 v129, s53, v129
    v_mfma_f32_32x32x16_bf16 v[80:95], v[48:51], v[60:63], v[80:95]
    ds_read_b64_tr_b16 v[48:49], v6 offset:4096
    ds_read_b64_tr_b16 v[50:51], v6 offset:5120
    v_xor_b32 v191, 4096, v129
    s_lshl_b32 s53, s64, 7
    v_mfma_f32_32x32x16_bf16 v[96:111], v[52:55], v[56:59], v[96:111]
    ds_read_b128 v[56:59], v3 offset:0
    s_add_u32 s66, s53, s59
    s_lshl_b32 s66, s66, 5
    s_mul_i32 s53, s51, 8320
    v_mfma_f32_32x32x16_bf16 v[112:127], v[52:55], v[60:63], v[112:127]
    ds_read_b128 v[60:63], v3 offset:4096
    ds_read_b64_tr_b16 v[52:53], v6 offset:4352
    ds_read_b64_tr_b16 v[54:55], v6 offset:5376
    s_add_u32 s66, s66, s53
    s_waitcnt lgkmcnt(6)
    v_mfma_f32_32x32x16_bf16 v[64:79], v[32:35], v[40:43], v[64:79]
    s_add_u32 s66, s66, 5767168
    s_lshl_b32 s63, s47, 2
    s_add_u32 s63, s63, s46
    v_mfma_f32_32x32x16_bf16 v[80:95], v[32:35], v[44:47], v[80:95]
    ds_read_b64_tr_b16 v[32:33], v6 offset:8192
    ds_read_b64_tr_b16 v[34:35], v6 offset:9216
    s_mul_i32 s65, s63, 114688
    s_mul_i32 s53, s49, 57344
    v_mfma_f32_32x32x16_bf16 v[96:111], v[36:39], v[40:43], v[96:111]
    ds_read_b128 v[40:43], v4 offset:0
    s_add_u32 s65, s65, s53
    s_add_u32 s65, s65, 8388608
    s_and_b32 s52, s45, 3
    v_mfma_f32_32x32x16_bf16 v[112:127], v[36:39], v[44:47], v[112:127]
    ds_read_b128 v[44:47], v4 offset:4096
    ds_read_b64_tr_b16 v[36:37], v6 offset:8448
    ds_read_b64_tr_b16 v[38:39], v6 offset:9472
    s_lshl_b32 s52, s52, 1
    s_waitcnt lgkmcnt(6)
    v_mfma_f32_32x32x16_bf16 v[64:79], v[48:51], v[56:59], v[64:79]
    ds_read2_b32 v[138:139], v254 offset0:64 offset1:128
    s_add_u32 s52, s52, s48
    s_sub_u32 s53, s52, 7
    s_cmp_ge_u32 s52, 7
    s_cselect_b32 s52, s53, s52
    v_mfma_f32_32x32x16_bf16 v[80:95], v[48:51], v[60:63], v[80:95]
    ds_read_b64_tr_b16 v[48:49], v6 offset:12288
    ds_read_b64_tr_b16 v[50:51], v6 offset:13312
    s_lshl_b32 s53, s52, 13
    s_add_u32 s20, s65, s53
    v_mfma_f32_32x32x16_bf16 v[96:111], v[52:55], v[56:59], v[96:111]
    ds_read_b128 v[56:59], v5 offset:0
    s_add_u32 s21, s20, 4096
    s_add_u32 s52, s52, 1
    s_cmp_eq_u32 s52, 7
    s_cselect_b32 s52, 0, s52
    v_mfma_f32_32x32x16_bf16 v[112:127], v[52:55], v[60:63], v[112:127]
    ds_read_b128 v[60:63], v5 offset:4096
    ds_read_b64_tr_b16 v[52:53], v6 offset:12544
    ds_read_b64_tr_b16 v[54:55], v6 offset:13568
    s_lshl_b32 s53, s52, 13
    s_waitcnt lgkmcnt(6)
    v_mfma_f32_32x32x16_bf16 v[64:79], v[32:35], v[40:43], v[64:79]
    v_min_u32 v138, v138, v139
    s_nop 0
    v_readfirstlane_b32 s58, v138
    s_nop 0
    s_cmp_lt_u32 s58, 6
    s_cbranch_scc1 Lcs19
Lcb20:
    v_mfma_f32_32x32x16_bf16 v[80:95], v[32:35], v[44:47], v[80:95]
    ds_read_b64_tr_b16 v[32:33], v6 offset:32768
    ds_read_b64_tr_b16 v[34:35], v6 offset:33792
    s_add_u32 s22, s65, s53
    s_add_u32 s23, s22, 4096
    v_mfma_f32_32x32x16_bf16 v[96:111], v[36:39], v[40:43], v[96:111]
    ds_read_b128 v[40:43], v2 offset:32768
    s_add_u32 s52, s52, 1
    s_cmp_eq_u32 s52, 7
    s_cselect_b32 s52, 0, s52
    s_lshl_b32 s53, s52, 13
    v_mfma_f32_32x32x16_bf16 v[112:127], v[36:39], v[44:47], v[112:127]
    ds_read_b128 v[44:47], v2 offset:36864
    ds_read_b64_tr_b16 v[36:37], v6 offset:33024
    ds_read_b64_tr_b16 v[38:39], v6 offset:34048
    s_add_u32 s24, s65, s53
    s_waitcnt lgkmcnt(6)
    v_mfma_f32_32x32x16_bf16 v[64:79], v[48:51], v[56:59], v[64:79]
    s_barrier
    s_add_u32 s25, s24, 4096
    s_add_u32 s52, s52, 1
    s_cmp_eq_u32 s52, 7
    s_cselect_b32 s52, 0, s52
    v_mfma_f32_32x32x16_bf16 v[80:95], v[48:51], v[60:63], v[80:95]
    ds_read_b64_tr_b16 v[48:49], v6 offset:36864
    ds_read_b64_tr_b16 v[50:51], v6 offset:37888
    s_lshl_b32 s53, s52, 13
    s_add_u32 s26, s65, s53
    v_mfma_f32_32x32x16_bf16 v[96:111], v[52:55], v[56:59], v[96:111]
    ds_read_b128 v[56:59], v3 offset:32768
    s_add_u32 s27, s26, 4096
    s_add_u32 s52, s52, 1
    s_cmp_eq_u32 s52, 7
    s_cselect_b32 s52, 0, s52
    v_mfma_f32_32x32x16_bf16 v[112:127], v[52:55], v[60:63], v[112:127]
    ds_read_b128 v[60:63], v3 offset:36864
    ds_read_b64_tr_b16 v[52:53], v6 offset:37120
    ds_read_b64_tr_b16 v[54:55], v6 offset:38144
    s_lshl_b32 s53, s52, 13
    s_waitcnt lgkmcnt(6)
    v_mfma_f32_32x32x16_bf16 v[64:79], v[32:35], v[40:43], v[64:79]
    s_add_u32 s28, s65, s53
    s_add_u32 s29, s28, 4096
    s_add_u32 s52, s52, 1
    v_mfma_f32_32x32x16_bf16 v[80:95], v[32:35], v[44:47], v[80:95]
    ds_read_b64_tr_b16 v[32:33], v6 offset:40960
    ds_read_b64_tr_b16 v[34:35], v6 offset:41984
    s_cmp_eq_u32 s52, 7
    s_cselect_b32 s52, 0, s52
    s_lshl_b32 s53, s52, 13
    v_mfma_f32_32x32x16_bf16 v[96:111], v[36:39], v[40:43], v[96:111]
    ds_read_b128 v[40:43], v4 offset:32768
    s_add_u32 s30, s65, s53
    s_add_u32 s31, s30, 4096
    s_add_u32 s52, s52, 1
    v_mfma_f32_32x32x16_bf16 v[112:127], v[36:39], v[44:47], v[112:127]
    ds_read_b128 v[44:47], v4 offset:36864
    ds_read_b64_tr_b16 v[36:37], v6 offset:41216
    ds_read_b64_tr_b16 v[38:39], v6 offset:42240
    s_cmp_eq_u32 s52, 7
    s_cselect_b32 s52, 0, s52
    s_waitcnt lgkmcnt(6)
    v_mfma_f32_32x32x16_bf16 v[64:79], v[48:51], v[56:59], v[64:79]
    ds_read2_b32 v[138:139], v254 offset0:64 offset1:128
    s_lshl_b32 s53, s52, 13
    s_add_u32 s32, s65, s53
    s_add_u32 s33, s32, 4096
    v_mfma_f32_32x32x16_bf16 v[80:95], v[48:51], v[60:63], v[80:95]
    ds_read_b64_tr_b16 v[48:49], v6 offset:45056
    ds_read_b64_tr_b16 v[50:51], v6 offset:46080
    s_lshl_b32 s61, s47, 1
    s_add_u32 s61, s61, s49
    v_mfma_f32_32x32x16_bf16 v[96:111], v[52:55], v[56:59], v[96:111]
    ds_read_b128 v[56:59], v5 offset:32768
    s_lshl_b32 s61, s61, 1
    s_add_u32 s61, s61, s64
    s_lshl_b32 s61, s61, 8
    v_mfma_f32_32x32x16_bf16 v[112:127], v[52:55], v[60:63], v[112:127]
    ds_read_b128 v[60:63], v5 offset:36864
    ds_read_b64_tr_b16 v[52:53], v6 offset:45312
    ds_read_b64_tr_b16 v[54:55], v6 offset:46336
    s_add_u32 s61, s61, 40960
    s_waitcnt lgkmcnt(6)
    v_mfma_f32_32x32x16_bf16 v[64:79], v[32:35], v[40:43], v[64:79]
    v_min_u32 v138, v138, v139
    v_mov_b32 v137, 6
    v_readfirstlane_b32 s58, v138
    v_xor_b32 v2, s69, v2
    v_xor_b32 v3, s69, v3
    v_xor_b32 v4, s69, v4
    v_xor_b32 v5, s69, v5
    v_xor_b32 v6, s69, v6
    s_cmp_lt_u32 s58, 7
    s_cbranch_scc1 Lcs21
Lcb22:
    v_mfma_f32_32x32x16_bf16 v[80:95], v[32:35], v[44:47], v[80:95]
    ds_read_b64_tr_b16 v[32:33], v6 offset:0
    ds_read_b64_tr_b16 v[34:35], v6 offset:1024
    s_lshl_b32 s53, s48, 4
    s_add_u32 s60, s61, s53
    v_mfma_f32_32x32x16_bf16 v[96:111], v[36:39], v[40:43], v[96:111]
    ds_read_b128 v[40:43], v2 offset:0
    s_lshr_b32 s53, s59, 1
    s_add_u32 s60, s60, s53
    v_min_u32 v132, 13, v0
    v_mfma_f32_32x32x16_bf16 v[112:127], v[36:39], v[44:47], v[112:127]
    ds_read_b128 v[44:47], v2 offset:4096
    ds_read_b64_tr_b16 v[36:37], v6 offset:256
    ds_read_b64_tr_b16 v[38:39], v6 offset:1280
    v_lshlrev_b32 v132, 3, v132
    s_waitcnt lgkmcnt(6)
    v_mfma_f32_32x32x16_bf16 v[64:79], v[48:51], v[56:59], v[64:79]
    ds_write_b32 v131, v137 offset:16
    v_lshlrev_b32 v248, 3, v0
    v_mov_b32 v250, s42
    v_mov_b32 v251, s43
    v_mfma_f32_32x32x16_bf16 v[80:95], v[48:51], v[60:63], v[80:95]
    ds_read_b64_tr_b16 v[48:49], v6 offset:4096
    ds_read_b64_tr_b16 v[50:51], v6 offset:5120
    v_mov_b32 v249, 0
    v_mfma_f32_32x32x16_bf16 v[96:111], v[52:55], v[56:59], v[96:111]
    ds_read_b128 v[56:59], v3 offset:0
    v_mfma_f32_32x32x16_bf16 v[112:127], v[52:55], v[60:63], v[112:127]
    ds_read_b128 v[60:63], v3 offset:4096
    ds_read_b64_tr_b16 v[52:53], v6 offset:4352
    ds_read_b64_tr_b16 v[54:55], v6 offset:5376
    s_waitcnt lgkmcnt(7)
    v_mfma_f32_32x32x16_bf16 v[64:79], v[32:35], v[40:43], v[64:79]
    v_mfma_f32_32x32x16_bf16 v[80:95], v[32:35], v[44:47], v[80:95]
    ds_read_b64_tr_b16 v[32:33], v6 offset:8192
    ds_read_b64_tr_b16 v[34:35], v6 offset:9216
    v_mfma_f32_32x32x16_bf16 v[96:111], v[36:39], v[40:43], v[96:111]
    ds_read_b128 v[40:43], v4 offset:0
    v_mfma_f32_32x32x16_bf16 v[112:127], v[36:39], v[44:47], v[112:127]
    ds_read_b128 v[44:47], v4 offset:4096
    ds_read_b64_tr_b16 v[36:37], v6 offset:8448
    ds_read_b64_tr_b16 v[38:39], v6 offset:9472
    s_waitcnt lgkmcnt(6)
    v_mfma_f32_32x32x16_bf16 v[64:79], v[48:51], v[56:59], v[64:79]
    ds_read2_b32 v[138:139], v254 offset0:64 offset1:128
    v_mfma_f32_32x32x16_bf16 v[80:95], v[48:51], v[60:63], v[80:95]
    ds_read_b64_tr_b16 v[48:49], v6 offset:12288
    ds_read_b64_tr_b16 v[50:51], v6 offset:13312
    v_mfma_f32_32x32x16_bf16 v[96:111], v[52:55], v[56:59], v[96:111]
    ds_read_b128 v[56:59], v5 offset:0
    v_mfma_f32_32x32x16_bf16 v[112:127], v[52:55], v[60:63], v[112:127]
    ds_read_b128 v[60:63], v5 offset:4096
    ds_read_b64_tr_b16 v[52:53], v6 offset:12544
    ds_read_b64_tr_b16 v[54:55], v6 offset:13568
    s_waitcnt lgkmcnt(6)
    v_mfma_f32_32x32x16_bf16 v[64:79], v[32:35], v[40:43], v[64:79]
    v_min_u32 v138, v138, v139
    v_mov_b32 v137, 7
    v_readfirstlane_b32 s58, v138
    s_nop 0
    s_cmp_lt_u32 s58, 8
    s_cbranch_scc1 Lcs23
Lcb24:
    v_mfma_f32_32x32x16_bf16 v[80:95], v[32:35], v[44:47], v[80:95]
    ds_read_b64_tr_b16 v[32:33], v6 offset:32768
    ds_read_b64_tr_b16 v[34:35], v6 offset:33792
    v_mfma_f32_32x32x16_bf16 v[96:111], v[36:39], v[40:43], v[96:111]
    ds_read_b128 v[40:43], v2 offset:32768
    v_mfma_f32_32x32x16_bf16 v[112:127], v[36:39], v[44:47], v[112:127]
    ds_read_b128 v[44:47], v2 offset:36864
    ds_read_b64_tr_b16 v[36:37], v6 offset:33024
    ds_read_b64_tr_b16 v[38:39], v6 offset:34048
    s_waitcnt lgkmcnt(6)
    v_mfma_f32_32x32x16_bf16 v[64:79], v[48:51], v[56:59], v[64:79]
    ds_write_b32 v131, v137 offset:16
    v_mfma_f32_32x32x16_bf16 v[80:95], v[48:51], v[60:63], v[80:95]
    ds_read_b64_tr_b16 v[48:49], v6 offset:36864
    ds_read_b64_tr_b16 v[50:51], v6 offset:37888
    v_mfma_f32_32x32x16_bf16 v[96:111], v[52:55], v[56:59], v[96:111]
    ds_read_b128 v[56:59], v3 offset:32768
    v_mfma_f32_32x32x16_bf16 v[112:127], v[52:55], v[60:63], v[112:127]
    ds_read_b128 v[60:63], v3 offset:36864
    ds_read_b64_tr_b16 v[52:53], v6 offset:37120
    ds_read_b64_tr_b16 v[54:55], v6 offset:38144
    s_waitcnt lgkmcnt(7)
    v_mfma_f32_32x32x16_bf16 v[64:79], v[32:35], v[40:43], v[64:79]
    v_mfma_f32_32x32x16_bf16 v[80:95], v[32:35], v[44:47], v[80:95]
    ds_read_b64_tr_b16 v[32:33], v6 offset:40960
    ds_read_b64_tr_b16 v[34:35], v6 offset:41984
    v_mfma_f32_32x32x16_bf16 v[96:111], v[36:39], v[40:43], v[96:111]
    ds_read_b128 v[40:43], v4 offset:32768
    v_mfma_f32_32x32x16_bf16 v[112:127], v[36:39], v[44:47], v[112:127]
    ds_read_b128 v[44:47], v4 offset:36864
    ds_read_b64_tr_b16 v[36:37], v6 offset:41216
    ds_read_b64_tr_b16 v[38:39], v6 offset:42240
    s_waitcnt lgkmcnt(6)
    v_mfma_f32_32x32x16_bf16 v[64:79], v[48:51], v[56:59], v[64:79]
    ds_read2_b32 v[138:139], v254 offset0:64 offset1:128
    v_mfma_f32_32x32x16_bf16 v[80:95], v[48:51], v[60:63], v[80:95]
    ds_read_b64_tr_b16 v[48:49], v6 offset:45056
    ds_read_b64_tr_b16 v[50:51], v6 offset:46080
    v_mfma_f32_32x32x16_bf16 v[96:111], v[52:55], v[56:59], v[96:111]
    ds_read_b128 v[56:59], v5 offset:32768
    v_mfma_f32_32x32x16_bf16 v[112:127], v[52:55], v[60:63], v[112:127]
    ds_read_b128 v[60:63], v5 offset:36864
    ds_read_b64_tr_b16 v[52:53], v6 offset:45312
    ds_read_b64_tr_b16 v[54:55], v6 offset:46336
    s_waitcnt lgkmcnt(6)
    v_mfma_f32_32x32x16_bf16 v[64:79], v[32:35], v[40:43], v[64:79]
    v_min_u32 v138, v138, v139
    v_mov_b32 v137, 8
    v_readfirstlane_b32 s58, v138
    s_nop 0
    s_cmp_lt_u32 s58, 9
    s_cbranch_scc1 Lcs25
Lcb26:
    ds_read_b128 v[204:207], v136 offset:0
    ds_read_b128 v[208:211], v136 offset:1024
    ds_read_b128 v[212:215], v136 offset:2048
    ds_read_b128 v[216:219], v136 offset:3072
    ds_read_b128 v[140:143], v135
    ds_read_b128 v[144:147], v134 offset:2048
    ds_read_b128 v[148:151], v134 offset:2560
    v_mfma_f32_32x32x16_bf16 v[80:95], v[32:35], v[44:47], v[80:95]
    v_cmp_gt_u32 s[52:53], 32, v0
    v_and_b32 v2, 16, v0
    v_cmp_eq_u32 s[36:37], 0, v2
    v_mov_b32 v223, 0
    v_mov_b32 v227, 0
    v_mov_b32 v231, 0
    v_mov_b32 v235, 0
    v_mfma_f32_32x32x16_bf16 v[96:111], v[36:39], v[40:43], v[96:111]
    v_mfma_f32_32x32x16_bf16 v[112:127], v[36:39], v[44:47], v[112:127]
    s_waitcnt lgkmcnt(0)
    ds_write_b32 v131, v137 offset:16
    v_mfma_f32_32x32x16_bf16 v[64:79], v[48:51], v[56:59], v[64:79]
    v_xor_b32 v143, s42, v143
    v_xor_b32 v147, s42, v147
    v_xor_b32 v151, s42, v151
    v_xor_b32 v206, s42, v206
    v_xor_b32 v210, s42, v210
    v_xor_b32 v214, s42, v214
    v_xor_b32 v218, s42, v218
    v_or3_b32 v138, v143, v147, v151
    v_or3_b32 v138, v138, v206, v210
    v_or3_b32 v138, v138, v214, v218
    v_cmp_ne_u32 vcc, 0, v138
    v_mfma_f32_32x32x16_bf16 v[80:95], v[48:51], v[60:63], v[80:95]
    s_cmp_lg_u64 vcc, 0
    s_cbranch_scc1 Lext_slow
Lext_ok:
    v_pk_add_f32 v[204:205], v[204:205], v[208:209]
    v_pk_add_f32 v[212:213], v[212:213], v[216:217]
    v_pk_add_f32 v[204:205], v[204:205], v[212:213]
    v_mfma_f32_32x32x16_bf16 v[96:111], v[52:55], v[56:59], v[96:111]
    v_cndmask_b32 v204, v205, v204, s[36:37]
    v_cvt_pk_bf16_f32 v208, v204, v204
    v_and_b32 v205, s3, v208
    v_sub_f32_e64 v205, v204, v205
    v_cvt_pk_bf16_f32 v209, v205, 0
    v_mfma_f32_32x32x16_bf16 v[112:127], v[52:55], v[60:63], v[112:127]
    v_lshl_or_b32 v209, v198, 16, v209
    v_mov_b32_e64 v210, v198
    v_cndmask_b32 v220, 0, v208, s[52:53]
    v_cndmask_b32 v221, 0, v209, s[52:53]
    v_cndmask_b32 v222, 0, v210, s[52:53]
    v_cndmask_b32 v232, v208, 0, s[52:53]
    v_cndmask_b32 v233, v209, 0, s[52:53]
    v_cndmask_b32 v234, v210, 0, s[52:53]
    v_mfma_f32_32x32x16_bf16 v[64:79], v[220:223], v[140:143], v[64:79]
    v_mov_b32 v224, v232
    v_mov_b32 v228, v220
    v_mov_b32 v225, v233
    v_mov_b32 v229, v221
    v_mov_b32 v226, v234
    v_mov_b32 v230, v222
    v_permlane32_swap_b32 v224, v228
    v_permlane32_swap_b32 v225, v229
    v_permlane32_swap_b32 v226, v230
    s_nop 1
    v_mfma_f32_32x32x16_bf16 v[80:95], v[224:227], v[140:143], v[80:95]
    v_pk_mul_f32 v[32:33], v[64:65], v[64:65]
    v_pk_mul_f32 v[34:35], v[66:67], v[66:67]
    v_pk_mul_f32 v[36:37], v[68:69], v[68:69]
    v_pk_mul_f32 v[38:39], v[70:71], v[70:71]
    v_pk_fma_f32 v[32:33], v[32:33], v[144:145], v[144:145] op_sel:[0,0,1] op_sel_hi:[1,0,1]
    v_pk_fma_f32 v[34:35], v[34:35], v[144:145], v[144:145] op_sel:[0,0,1] op_sel_hi:[1,0,1]
    v_pk_fma_f32 v[36:37], v[36:37], v[144:145], v[144:145] op_sel:[0,0,1] op_sel_hi:[1,0,1]
    v_pk_fma_f32 v[38:39], v[38:39], v[144:145], v[144:145] op_sel:[0,0,1] op_sel_hi:[1,0,1]
    s_nop 1
    v_mfma_f32_32x32x16_bf16 v[96:111], v[228:231], v[140:143], v[96:111]
    v_pk_mul_f32 v[32:33], v[32:33], v[64:65]
    v_pk_mul_f32 v[34:35], v[34:35], v[66:67]
    v_pk_mul_f32 v[36:37], v[36:37], v[68:69]
    v_pk_mul_f32 v[38:39], v[38:39], v[70:71]
    v_exp_f32 v32, v32
    v_exp_f32 v33, v33
    v_exp_f32 v34, v34
    v_exp_f32 v35, v35
    v_exp_f32 v36, v36
    v_exp_f32 v37, v37
    v_exp_f32 v38, v38
    v_exp_f32_e64 v39, v39
    v_mfma_f32_32x32x16_bf16 v[112:127], v[232:235], v[140:143], v[112:127]
    v_pk_fma_f32 v[32:33], v[32:33], v[146:147], v[146:147] op_sel_hi:[1,0,0]
    v_pk_fma_f32 v[34:35], v[34:35], v[146:147], v[146:147] op_sel_hi:[1,0,0]
    v_pk_fma_f32 v[36:37], v[36:37], v[146:147], v[146:147] op_sel_hi:[1,0,0]
    v_pk_fma_f32 v[38:39], v[38:39], v[146:147], v[146:147] op_sel_hi:[1,0,0]
    v_rcp_f32 v32, v32
    v_rcp_f32 v33, v33
    v_rcp_f32 v34, v34
    v_rcp_f32 v35, v35
    v_rcp_f32 v36, v36
    v_rcp_f32 v37, v37
    v_rcp_f32 v38, v38
    v_rcp_f32 v39, v39
    v_pk_mul_f32 v[32:33], v[32:33], v[64:65]
    v_pk_mul_f32 v[34:35], v[34:35], v[66:67]
    v_pk_mul_f32 v[36:37], v[36:37], v[68:69]
    v_pk_mul_f32 v[38:39], v[38:39], v[70:71]
    v_cvt_pk_bf16_f32 v40, v32, v33
    v_cvt_pk_bf16_f32 v41, v34, v35
    v_cvt_pk_bf16_f32 v42, v36, v37
    v_cvt_pk_bf16_f32 v43, v38, v39
    buffer_store_dwordx4 v[40:43], v1, s[12:15], s67 offen offset:0 sc1
    v_pk_mul_f32 v[32:33], v[72:73], v[72:73]
    v_pk_mul_f32 v[34:35], v[74:75], v[74:75]
    v_pk_mul_f32 v[36:37], v[76:77], v[76:77]
    v_pk_mul_f32 v[38:39], v[78:79], v[78:79]
    v_pk_fma_f32 v[32:33], v[32:33], v[144:145], v[144:145] op_sel:[0,0,1] op_sel_hi:[1,0,1]
    v_pk_fma_f32 v[34:35], v[34:35], v[144:145], v[144:145] op_sel:[0,0,1] op_sel_hi:[1,0,1]
    v_pk_fma_f32 v[36:37], v[36:37], v[144:145], v[144:145] op_sel:[0,0,1] op_sel_hi:[1,0,1]
    v_pk_fma_f32 v[38:39], v[38:39], v[144:145], v[144:145] op_sel:[0,0,1] op_sel_hi:[1,0,1]
    v_pk_mul_f32 v[32:33], v[32:33], v[72:73]
    v_pk_mul_f32 v[34:35], v[34:35], v[74:75]
    v_pk_mul_f32 v[36:37], v[36:37], v[76:77]
    v_pk_mul_f32 v[38:39], v[38:39], v[78:79]
    v_exp_f32 v32, v32
    v_exp_f32 v33, v33
    v_exp_f32 v34, v34
    v_exp_f32 v35, v35
    v_exp_f32 v36, v36
    v_exp_f32 v37, v37
    v_exp_f32 v38, v38
    v_exp_f32 v39, v39
    v_pk_fma_f32 v[32:33], v[32:33], v[146:147], v[146:147] op_sel_hi:[1,0,0]
    v_pk_fma_f32 v[34:35], v[34:35], v[146:147], v[146:147] op_sel_hi:[1,0,0]
    v_pk_fma_f32 v[36:37], v[36:37], v[146:147], v[146:147] op_sel_hi:[1,0,0]
    v_pk_fma_f32 v[38:39], v[38:39], v[146:147], v[146:147] op_sel_hi:[1,0,0]
    v_rcp_f32 v32, v32
    v_rcp_f32 v33, v33
    v_rcp_f32 v34, v34
    v_rcp_f32 v35, v35
    v_rcp_f32 v36, v36
    v_rcp_f32 v37, v37
    v_rcp_f32 v38, v38
    v_rcp_f32 v39, v39
    v_pk_mul_f32 v[32:33], v[32:33], v[72:73]
    v_pk_mul_f32 v[34:35], v[34:35], v[74:75]
    v_pk_mul_f32 v[36:37], v[36:37], v[76:77]
    v_pk_mul_f32 v[38:39], v[38:39], v[78:79]
    v_cvt_pk_bf16_f32 v44, v32, v33
    v_cvt_pk_bf16_f32 v45, v34, v35
    v_cvt_pk_bf16_f32 v46, v36, v37
    v_cvt_pk_bf16_f32 v47, v38, v39
    buffer_store_dwordx4 v[44:47], v1, s[12:15], s67 offen offset:1024 sc1
    v_pk_mul_f32 v[32:33], v[80:81], v[80:81]
    v_pk_mul_f32 v[34:35], v[82:83], v[82:83]
    v_pk_mul_f32 v[36:37], v[84:85], v[84:85]
    v_pk_mul_f32 v[38:39], v[86:87], v[86:87]
    v_pk_fma_f32 v[32:33], v[32:33], v[148:149], v[148:149] op_sel:[0,0,1] op_sel_hi:[1,0,1]
    v_pk_fma_f32 v[34:35], v[34:35], v[148:149], v[148:149] op_sel:[0,0,1] op_sel_hi:[1,0,1]
    v_pk_fma_f32 v[36:37], v[36:37], v[148:149], v[148:149] op_sel:[0,0,1] op_sel_hi:[1,0,1]
    v_pk_fma_f32 v[38:39], v[38:39], v[148:149], v[148:149] op_sel:[0,0,1] op_sel_hi:[1,0,1]
    v_pk_mul_f32 v[32:33], v[32:33], v[80:81]
    v_pk_mul_f32 v[34:35], v[34:35], v[82:83]
    v_pk_mul_f32 v[36:37], v[36:37], v[84:85]
    v_pk_mul_f32 v[38:39], v[38:39], v[86:87]
    v_exp_f32 v32, v32
    v_exp_f32 v33, v33
    v_exp_f32 v34, v34
    v_exp_f32 v35, v35
    v_exp_f32 v36, v36
    v_exp_f32 v37, v37
    v_exp_f32 v38, v38
    v_exp_f32 v39, v39
    v_pk_fma_f32 v[32:33], v[32:33], v[150:151], v[150:151] op_sel_hi:[1,0,0]
    v_pk_fma_f32 v[34:35], v[34:35], v[150:151], v[150:151] op_sel_hi:[1,0,0]
    v_pk_fma_f32 v[36:37], v[36:37], v[150:151], v[150:151] op_sel_hi:[1,0,0]
    v_pk_fma_f32 v[38:39], v[38:39], v[150:151], v[150:151] op_sel_hi:[1,0,0]
    v_rcp_f32 v32, v32
    v_rcp_f32 v33, v33
    v_rcp_f32 v34, v34
    v_rcp_f32 v35, v35
    v_rcp_f32 v36, v36
    v_rcp_f32 v37, v37
    v_rcp_f32 v38, v38
    v_rcp_f32 v39, v39
    v_pk_mul_f32 v[32:33], v[32:33], v[80:81]
    v_pk_mul_f32 v[34:35], v[34:35], v[82:83]
    v_pk_mul_f32 v[36:37], v[36:37], v[84:85]
    v_pk_mul_f32 v[38:39], v[38:39], v[86:87]
    v_cvt_pk_bf16_f32 v40, v32, v33
    v_cvt_pk_bf16_f32 v41, v34, v35
    v_cvt_pk_bf16_f32 v42, v36, v37
    v_cvt_pk_bf16_f32 v43, v38, v39
    buffer_store_dwordx4 v[40:43], v1, s[12:15], s68 offen offset:0 sc1
    v_pk_mul_f32 v[32:33], v[88:89], v[88:89]
    v_pk_mul_f32 v[34:35], v[90:91], v[90:91]
    v_pk_mul_f32 v[36:37], v[92:93], v[92:93]
    v_pk_mul_f32 v[38:39], v[94:95], v[94:95]
    v_pk_fma_f32 v[32:33], v[32:33], v[148:149], v[148:149] op_sel:[0,0,1] op_sel_hi:[1,0,1]
    v_pk_fma_f32 v[34:35], v[34:35], v[148:149], v[148:149] op_sel:[0,0,1] op_sel_hi:[1,0,1]
    v_pk_fma_f32 v[36:37], v[36:37], v[148:149], v[148:149] op_sel:[0,0,1] op_sel_hi:[1,0,1]
    v_pk_fma_f32 v[38:39], v[38:39], v[148:149], v[148:149] op_sel:[0,0,1] op_sel_hi:[1,0,1]
    v_pk_mul_f32 v[32:33], v[32:33], v[88:89]
    v_pk_mul_f32 v[34:35], v[34:35], v[90:91]
    v_pk_mul_f32 v[36:37], v[36:37], v[92:93]
    v_pk_mul_f32 v[38:39], v[38:39], v[94:95]
    v_exp_f32 v32, v32
    v_exp_f32 v33, v33
    v_exp_f32 v34, v34
    v_exp_f32 v35, v35
    v_exp_f32 v36, v36
    v_exp_f32 v37, v37
    v_exp_f32 v38, v38
    v_exp_f32 v39, v39
    v_pk_fma_f32 v[32:33], v[32:33], v[150:151], v[150:151] op_sel_hi:[1,0,0]
    v_pk_fma_f32 v[34:35], v[34:35], v[150:151], v[150:151] op_sel_hi:[1,0,0]
    v_pk_fma_f32 v[36:37], v[36:37], v[150:151], v[150:151] op_sel_hi:[1,0,0]
    v_pk_fma_f32 v[38:39], v[38:39], v[150:151], v[150:151] op_sel_hi:[1,0,0]
    v_rcp_f32 v32, v32
    v_rcp_f32 v33, v33
    v_rcp_f32 v34, v34
    v_rcp_f32 v35, v35
    v_rcp_f32 v36, v36
    v_rcp_f32 v37, v37
    v_rcp_f32 v38, v38
    v_rcp_f32 v39, v39
    v_pk_mul_f32 v[32:33], v[32:33], v[88:89]
    v_pk_mul_f32 v[34:35], v[34:35], v[90:91]
    v_pk_mul_f32 v[36:37], v[36:37], v[92:93]
    v_pk_mul_f32 v[38:39], v[38:39], v[94:95]
    v_cvt_pk_bf16_f32 v44, v32, v33
    v_cvt_pk_bf16_f32 v45, v34, v35
    v_cvt_pk_bf16_f32 v46, v36, v37
    v_cvt_pk_bf16_f32 v47, v38, v39
    buffer_store_dwordx4 v[44:47], v1, s[12:15], s68 offen offset:1024 sc1
    v_pk_mul_f32 v[32:33], v[96:97], v[96:97]
    v_pk_mul_f32 v[34:35], v[98:99], v[98:99]
    v_pk_mul_f32 v[36:37], v[100:101], v[100:101]
    v_pk_mul_f32 v[38:39], v[102:103], v[102:103]
    v_pk_fma_f32 v[32:33], v[32:33], v[144:145], v[144:145] op_sel:[0,0,1] op_sel_hi:[1,0,1]
    v_pk_fma_f32 v[34:35], v[34:35], v[144:145], v[144:145] op_sel:[0,0,1] op_sel_hi:[1,0,1]
    v_pk_fma_f32 v[36:37], v[36:37], v[144:145], v[144:145] op_sel:[0,0,1] op_sel_hi:[1,0,1]
    v_pk_fma_f32 v[38:39], v[38:39], v[144:145], v[144:145] op_sel:[0,0,1] op_sel_hi:[1,0,1]
    v_pk_mul_f32 v[32:33], v[32:33], v[96:97]
    v_pk_mul_f32 v[34:35], v[34:35], v[98:99]
    v_pk_mul_f32 v[36:37], v[36:37], v[100:101]
    v_pk_mul_f32 v[38:39], v[38:39], v[102:103]
    v_exp_f32 v32, v32
    v_exp_f32 v33, v33
    v_exp_f32 v34, v34
    v_exp_f32 v35, v35
    v_exp_f32 v36, v36
    v_exp_f32 v37, v37
    v_exp_f32 v38, v38
    v_exp_f32 v39, v39
    v_pk_fma_f32 v[32:33], v[32:33], v[146:147], v[146:147] op_sel_hi:[1,0,0]
    v_pk_fma_f32 v[34:35], v[34:35], v[146:147], v[146:147] op_sel_hi:[1,0,0]
    v_pk_fma_f32 v[36:37], v[36:37], v[146:147], v[146:147] op_sel_hi:[1,0,0]
    v_pk_fma_f32 v[38:39], v[38:39], v[146:147], v[146:147] op_sel_hi:[1,0,0]
    v_rcp_f32 v32, v32
    v_rcp_f32 v33, v33
    v_rcp_f32 v34, v34
    v_rcp_f32 v35, v35
    v_rcp_f32 v36, v36
    v_rcp_f32 v37, v37
    v_rcp_f32 v38, v38
    v_rcp_f32 v39, v39
    v_pk_mul_f32 v[32:33], v[32:33], v[96:97]
    v_pk_mul_f32 v[34:35], v[34:35], v[98:99]
    v_pk_mul_f32 v[36:37], v[36:37], v[100:101]
    v_pk_mul_f32 v[38:39], v[38:39], v[102:103]
    v_cvt_pk_bf16_f32 v40, v32, v33
    v_cvt_pk_bf16_f32 v41, v34, v35
    v_cvt_pk_bf16_f32 v42, v36, v37
    v_cvt_pk_bf16_f32 v43, v38, v39
    buffer_store_dwordx4 v[40:43], v1, s[12:15], s67 offen offset:2048 sc1
    v_pk_mul_f32 v[32:33], v[104:105], v[104:105]
    v_pk_mul_f32 v[34:35], v[106:107], v[106:107]
    v_pk_mul_f32 v[36:37], v[108:109], v[108:109]
    v_pk_mul_f32 v[38:39], v[110:111], v[110:111]
    v_pk_fma_f32 v[32:33], v[32:33], v[144:145], v[144:145] op_sel:[0,0,1] op_sel_hi:[1,0,1]
    v_pk_fma_f32 v[34:35], v[34:35], v[144:145], v[144:145] op_sel:[0,0,1] op_sel_hi:[1,0,1]
    v_pk_fma_f32 v[36:37], v[36:37], v[144:145], v[144:145] op_sel:[0,0,1] op_sel_hi:[1,0,1]
    v_pk_fma_f32 v[38:39], v[38:39], v[144:145], v[144:145] op_sel:[0,0,1] op_sel_hi:[1,0,1]
    v_pk_mul_f32 v[32:33], v[32:33], v[104:105]
    v_pk_mul_f32 v[34:35], v[34:35], v[106:107]
    v_pk_mul_f32 v[36:37], v[36:37], v[108:109]
    v_pk_mul_f32 v[38:39], v[38:39], v[110:111]
    v_exp_f32 v32, v32
    v_exp_f32 v33, v33
    v_exp_f32 v34, v34
    v_exp_f32 v35, v35
    v_exp_f32 v36, v36
    v_exp_f32 v37, v37
    v_exp_f32 v38, v38
    v_exp_f32 v39, v39
    v_pk_fma_f32 v[32:33], v[32:33], v[146:147], v[146:147] op_sel_hi:[1,0,0]
    v_pk_fma_f32 v[34:35], v[34:35], v[146:147], v[146:147] op_sel_hi:[1,0,0]
    v_pk_fma_f32 v[36:37], v[36:37], v[146:147], v[146:147] op_sel_hi:[1,0,0]
    v_pk_fma_f32 v[38:39], v[38:39], v[146:147], v[146:147] op_sel_hi:[1,0,0]
    v_rcp_f32 v32, v32
    v_rcp_f32 v33, v33
    v_rcp_f32 v34, v34
    v_rcp_f32 v35, v35
    v_rcp_f32 v36, v36
    v_rcp_f32 v37, v37
    v_rcp_f32 v38, v38
    v_rcp_f32 v39, v39
    v_pk_mul_f32 v[32:33], v[32:33], v[104:105]
    v_pk_mul_f32 v[34:35], v[34:35], v[106:107]
    v_pk_mul_f32 v[36:37], v[36:37], v[108:109]
    v_pk_mul_f32 v[38:39], v[38:39], v[110:111]
    v_cvt_pk_bf16_f32 v44, v32, v33
    v_cvt_pk_bf16_f32 v45, v34, v35
    v_cvt_pk_bf16_f32 v46, v36, v37
    v_cvt_pk_bf16_f32 v47, v38, v39
    buffer_store_dwordx4 v[44:47], v1, s[12:15], s67 offen offset:3072 sc1
    v_pk_mul_f32 v[32:33], v[112:113], v[112:113]
    v_pk_mul_f32 v[34:35], v[114:115], v[114:115]
    v_pk_mul_f32 v[36:37], v[116:117], v[116:117]
    v_pk_mul_f32 v[38:39], v[118:119], v[118:119]
    v_pk_fma_f32 v[32:33], v[32:33], v[148:149], v[148:149] op_sel:[0,0,1] op_sel_hi:[1,0,1]
    v_pk_fma_f32 v[34:35], v[34:35], v[148:149], v[148:149] op_sel:[0,0,1] op_sel_hi:[1,0,1]
    v_pk_fma_f32 v[36:37], v[36:37], v[148:149], v[148:149] op_sel:[0,0,1] op_sel_hi:[1,0,1]
    v_pk_fma_f32 v[38:39], v[38:39], v[148:149], v[148:149] op_sel:[0,0,1] op_sel_hi:[1,0,1]
    v_pk_mul_f32 v[32:33], v[32:33], v[112:113]
    v_pk_mul_f32 v[34:35], v[34:35], v[114:115]
    v_pk_mul_f32 v[36:37], v[36:37], v[116:117]
    v_pk_mul_f32 v[38:39], v[38:39], v[118:119]
    v_exp_f32 v32, v32
    v_exp_f32 v33, v33
    v_exp_f32 v34, v34
    v_exp_f32 v35, v35
    v_exp_f32 v36, v36
    v_exp_f32 v37, v37
    v_exp_f32 v38, v38
    v_exp_f32 v39, v39
    v_pk_fma_f32 v[32:33], v[32:33], v[150:151], v[150:151] op_sel_hi:[1,0,0]
    v_pk_fma_f32 v[34:35], v[34:35], v[150:151], v[150:151] op_sel_hi:[1,0,0]
    v_pk_fma_f32 v[36:37], v[36:37], v[150:151], v[150:151] op_sel_hi:[1,0,0]
    v_pk_fma_f32 v[38:39], v[38:39], v[150:151], v[150:151] op_sel_hi:[1,0,0]
    v_rcp_f32 v32, v32
    v_rcp_f32 v33, v33
    v_rcp_f32 v34, v34
    v_rcp_f32 v35, v35
    v_rcp_f32 v36, v36
    v_rcp_f32 v37, v37
    v_rcp_f32 v38, v38
    v_rcp_f32 v39, v39
    v_pk_mul_f32 v[32:33], v[32:33], v[112:113]
    v_pk_mul_f32 v[34:35], v[34:35], v[114:115]
    v_pk_mul_f32 v[36:37], v[36:37], v[116:117]
    v_pk_mul_f32 v[38:39], v[38:39], v[118:119]
    v_cvt_pk_bf16_f32 v40, v32, v33
    v_cvt_pk_bf16_f32 v41, v34, v35
    v_cvt_pk_bf16_f32 v42, v36, v37
    v_cvt_pk_bf16_f32 v43, v38, v39
    buffer_store_dwordx4 v[40:43], v1, s[12:15], s68 offen offset:2048 sc1
    ds_read2_b32 v[138:139], v254 offset0:64 offset1:128
    ds_read_b128 v[240:243], v128
    ds_read_b128 v[244:247], v128 offset:4096
    v_pk_mul_f32 v[32:33], v[120:121], v[120:121]
    v_pk_mul_f32 v[34:35], v[122:123], v[122:123]
    v_pk_mul_f32 v[36:37], v[124:125], v[124:125]
    v_pk_mul_f32 v[38:39], v[126:127], v[126:127]
    v_pk_fma_f32 v[32:33], v[32:33], v[148:149], v[148:149] op_sel:[0,0,1] op_sel_hi:[1,0,1]
    v_pk_fma_f32 v[34:35], v[34:35], v[148:149], v[148:149] op_sel:[0,0,1] op_sel_hi:[1,0,1]
    v_pk_fma_f32 v[36:37], v[36:37], v[148:149], v[148:149] op_sel:[0,0,1] op_sel_hi:[1,0,1]
    v_pk_fma_f32 v[38:39], v[38:39], v[148:149], v[148:149] op_sel:[0,0,1] op_sel_hi:[1,0,1]
    v_pk_mul_f32 v[32:33], v[32:33], v[120:121]
    v_pk_mul_f32 v[34:35], v[34:35], v[122:123]
    v_pk_mul_f32 v[36:37], v[36:37], v[124:125]
    v_pk_mul_f32 v[38:39], v[38:39], v[126:127]
    v_exp_f32 v32, v32
    v_exp_f32 v33, v33
    v_exp_f32 v34, v34
    v_exp_f32 v35, v35
    v_exp_f32 v36, v36
    v_exp_f32 v37, v37
    v_exp_f32 v38, v38
    v_exp_f32 v39, v39
    v_pk_fma_f32 v[32:33], v[32:33], v[150:151], v[150:151] op_sel_hi:[1,0,0]
    v_pk_fma_f32 v[34:35], v[34:35], v[150:151], v[150:151] op_sel_hi:[1,0,0]
    v_pk_fma_f32 v[36:37], v[36:37], v[150:151], v[150:151] op_sel_hi:[1,0,0]
    v_pk_fma_f32 v[38:39], v[38:39], v[150:151], v[150:151] op_sel_hi:[1,0,0]
    v_rcp_f32 v32, v32
    v_rcp_f32 v33, v33
    v_rcp_f32 v34, v34
    v_rcp_f32 v35, v35
    v_rcp_f32 v36, v36
    v_rcp_f32 v37, v37
    v_rcp_f32 v38, v38
    v_rcp_f32 v39, v39
    v_pk_mul_f32 v[32:33], v[32:33], v[120:121]
    v_pk_mul_f32 v[34:35], v[34:35], v[122:123]
    v_pk_mul_f32 v[36:37], v[36:37], v[124:125]
    v_pk_mul_f32 v[38:39], v[38:39], v[126:127]
    v_cvt_pk_bf16_f32 v44, v32, v33
    v_cvt_pk_bf16_f32 v45, v34, v35
    v_cvt_pk_bf16_f32 v46, v36, v37
    v_cvt_pk_bf16_f32 v47, v38, v39
    buffer_store_dwordx4 v[44:47], v1, s[12:15], s68 offen offset:3072 sc1
    s_waitcnt vmcnt(4)
    s_mov_b64 exec, 1
    buffer_store_dwordx2 v[250:251], v249, s[12:15], s60 offen offset:0 sc1
    s_mov_b64 exec, -1
    s_waitcnt lgkmcnt(0)
Lcol:
    v_min_u32 v138, v138, v139
    s_nop 0
    v_readfirstlane_b32 s58, v138
    s_nop 0
    s_cmp_lt_u32 s58, 10
    s_cbranch_scc1 Lcs27
Lcb28:
    v_dot2_f32_bf16 v32, v240, s56, 0
    v_dot2_f32_bf16 v36, v240, s56, 0 neg_lo:[0,1,0]
    v_dot2_f32_bf16 v40, v240, v176, 0 neg_hi:[0,1,0]
    v_dot2_f32_bf16 v44, v240, v180, 0
    v_dot2_f32_bf16 v32, v241, s56, v32
    v_dot2_f32_bf16 v36, v241, s56, v36 neg_hi:[0,1,0]
    v_dot2_f32_bf16 v40, v241, v180, v40 neg_hi:[0,1,0]
    v_dot2_f32_bf16 v44, v241, v176, v44 neg_lo:[0,1,0] neg_hi:[0,1,0]
    v_dot2_f32_bf16 v33, v242, s56, 0
    v_dot2_f32_bf16 v37, v242, s56, 0 neg_lo:[0,1,0]
    v_dot2_f32_bf16 v41, v242, v177, 0 neg_hi:[0,1,0]
    v_dot2_f32_bf16 v45, v242, v181, 0
    v_dot2_f32_bf16 v33, v243, s56, v33
    v_dot2_f32_bf16 v37, v243, s56, v37 neg_hi:[0,1,0]
    v_dot2_f32_bf16 v41, v243, v181, v41 neg_hi:[0,1,0]
    v_dot2_f32_bf16 v45, v243, v177, v45 neg_lo:[0,1,0] neg_hi:[0,1,0]
    v_dot2_f32_bf16 v34, v244, s56, 0
    v_dot2_f32_bf16 v38, v244, s56, 0 neg_lo:[0,1,0]
    v_dot2_f32_bf16 v42, v244, v178, 0 neg_hi:[0,1,0]
    v_dot2_f32_bf16 v46, v244, v182, 0
    v_dot2_f32_bf16 v34, v245, s56, v34
    v_dot2_f32_bf16 v38, v245, s56, v38 neg_hi:[0,1,0]
    v_dot2_f32_bf16 v42, v245, v182, v42 neg_hi:[0,1,0]
    v_dot2_f32_bf16 v46, v245, v178, v46 neg_lo:[0,1,0] neg_hi:[0,1,0]
    v_dot2_f32_bf16 v35, v246, s56, 0
    v_dot2_f32_bf16 v39, v246, s56, 0 neg_lo:[0,1,0]
    v_dot2_f32_bf16 v43, v246, v179, 0 neg_hi:[0,1,0]
    v_dot2_f32_bf16 v47, v246, v183, 0
    v_dot2_f32_bf16 v35, v247, s56, v35
    v_dot2_f32_bf16 v39, v247, s56, v39 neg_hi:[0,1,0]
    v_dot2_f32_bf16 v43, v247, v183, v43 neg_hi:[0,1,0]
    v_dot2_f32_bf16 v47, v247, v179, v47 neg_lo:[0,1,0] neg_hi:[0,1,0]
    v_cvt_pk_bf16_f32 v48, v32, v33
    v_cvt_pk_bf16_f32 v50, v36, v37
    v_cvt_pk_bf16_f32 v52, v40, v41
    v_cvt_pk_bf16_f32 v54, v44, v45
    ds_write2_b32 v196, v48, v50 offset0:0 offset1:2
    ds_write2_b32 v197, v52, v54 offset0:0 offset1:2
    v_cvt_pk_bf16_f32 v49, v34, v35
    v_cvt_pk_bf16_f32 v51, v38, v39
    v_cvt_pk_bf16_f32 v53, v42, v43
    v_cvt_pk_bf16_f32 v55, v46, v47
    ds_write2_b32 v196, v49, v51 offset0:128 offset1:130
    ds_write2_b32 v197, v53, v55 offset0:128 offset1:130
    s_waitcnt lgkmcnt(0)
    s_barrier
    ds_read_b128 v[220:223], v184
    ds_read_b128 v[228:231], v186
    ds_read_b128 v[224:227], v185
    ds_read_b128 v[232:235], v187
    s_waitcnt lgkmcnt(2)
    v_mfma_f32_16x16x32_bf16 v[64:67], v[220:223], v[10:13], 0
    v_mfma_f32_16x16x32_bf16 v[68:71], v[220:223], v[8:11], 0
    v_mfma_f32_16x16x32_bf16 v[64:67], v[228:231], v[16:19], v[64:67]
    v_mfma_f32_16x16x32_bf16 v[68:71], v[228:231], v[14:17], v[68:71]
    s_waitcnt lgkmcnt(0)
    v_mfma_f32_16x16x32_bf16 v[72:75], v[224:227], v[10:13], 0
    v_mfma_f32_16x16x32_bf16 v[76:79], v[224:227], v[8:11], 0
    v_mfma_f32_16x16x32_bf16 v[72:75], v[232:235], v[16:19], v[72:75]
    v_mfma_f32_16x16x32_bf16 v[76:79], v[232:235], v[14:17], v[76:79]
    ds_read_b32 v138, v254 offset:512
    ds_read2_b32 v[200:201], v129 offset0:0 offset1:64
    ds_read2_b32 v[202:203], v129 offset0:128 offset1:192
    ds_read2_b32 v[204:205], v191 offset0:0 offset1:64
    ds_read2_b32 v[206:207], v191 offset0:128 offset1:192
    v_pk_mul_f32 v[80:81], v[68:69], v[160:161]
    v_pk_mul_f32 v[84:85], v[64:65], v[160:161]
    v_pk_mul_f32 v[82:83], v[70:71], v[162:163]
    v_pk_mul_f32 v[86:87], v[66:67], v[162:163]
    v_pk_fma_f32 v[80:81], v[64:65], v[152:153], v[80:81]
    v_pk_fma_f32 v[84:85], v[68:69], v[152:153], v[84:85] neg_lo:[0,0,1] neg_hi:[0,0,1]
    v_pk_fma_f32 v[82:83], v[66:67], v[154:155], v[82:83]
    v_pk_fma_f32 v[86:87], v[70:71], v[154:155], v[86:87] neg_lo:[0,0,1] neg_hi:[0,0,1]
    v_cvt_pk_bf16_f32 v48, v80, v81
    v_cvt_pk_bf16_f32 v49, v82, v83
    v_cvt_pk_bf16_f32 v50, v84, v85
    v_cvt_pk_bf16_f32 v51, v86, v87
    s_nop 0
    s_nop 0
    v_mfma_f32_16x16x32_bf16 v[96:99], v[10:13], v[48:51], 0
    v_mfma_f32_16x16x32_bf16 v[100:103], v[8:11], v[48:51], 0
    v_mfma_f32_16x16x32_bf16 v[104:107], v[22:25], v[48:51], 0
    v_mfma_f32_16x16x32_bf16 v[108:111], v[20:23], v[48:51], 0
    v_pk_mul_f32 v[88:89], v[76:77], v[164:165]
    v_pk_mul_f32 v[92:93], v[72:73], v[164:165]
    v_pk_mul_f32 v[90:91], v[78:79], v[166:167]
    v_pk_mul_f32 v[94:95], v[74:75], v[166:167]
    v_pk_fma_f32 v[88:89], v[72:73], v[156:157], v[88:89]
    v_pk_fma_f32 v[92:93], v[76:77], v[156:157], v[92:93] neg_lo:[0,0,1] neg_hi:[0,0,1]
    v_pk_fma_f32 v[90:91], v[74:75], v[158:159], v[90:91]
    v_pk_fma_f32 v[94:95], v[78:79], v[158:159], v[94:95] neg_lo:[0,0,1] neg_hi:[0,0,1]
    v_cvt_pk_bf16_f32 v52, v88, v89
    v_cvt_pk_bf16_f32 v53, v90, v91
    v_cvt_pk_bf16_f32 v54, v92, v93
    v_cvt_pk_bf16_f32 v55, v94, v95
    s_waitcnt lgkmcnt(0)
    v_readfirstlane_b32 s58, v138
    s_nop 0
    s_cmp_lt_u32 s58, 11
    s_cbranch_scc1 Lcs29
Lcb30:
    v_mfma_f32_16x16x32_bf16 v[96:99], v[16:19], v[52:55], v[96:99]
    v_mfma_f32_16x16x32_bf16 v[100:103], v[14:17], v[52:55], v[100:103]
    v_mfma_f32_16x16x32_bf16 v[104:107], v[28:31], v[52:55], v[104:107]
    v_mfma_f32_16x16x32_bf16 v[108:111], v[26:29], v[52:55], v[108:111]
    v_lshlrev_b32 v112, 16, v200
    v_lshlrev_b32 v113, 16, v201
    v_lshlrev_b32 v114, 16, v202
    v_lshlrev_b32 v115, 16, v203
    v_lshlrev_b32 v116, 16, v204
    v_lshlrev_b32 v117, 16, v205
    v_lshlrev_b32 v118, 16, v206
    v_lshlrev_b32 v119, 16, v207
    v_and_b32 v120, s3, v200
    v_and_b32 v121, s3, v201
    v_and_b32 v122, s3, v202
    v_and_b32 v123, s3, v203
    v_and_b32 v124, s3, v204
    v_and_b32 v125, s3, v205
    v_and_b32 v126, s3, v206
    v_and_b32_e64 v127, s3, v207
    v_pk_mul_f32 v[80:81], v[100:101], v[120:121]
    v_pk_mul_f32 v[84:85], v[96:97], v[120:121]
    v_pk_mul_f32 v[82:83], v[102:103], v[122:123]
    v_pk_mul_f32 v[86:87], v[98:99], v[122:123]
    v_pk_fma_f32 v[80:81], v[96:97], v[112:113], v[80:81] neg_lo:[0,0,1] neg_hi:[0,0,1]
    v_pk_fma_f32 v[84:85], v[100:101], v[112:113], v[84:85]
    v_pk_fma_f32 v[82:83], v[98:99], v[114:115], v[82:83] neg_lo:[0,0,1] neg_hi:[0,0,1]
    v_pk_fma_f32 v[86:87], v[102:103], v[114:115], v[86:87]
    v_cvt_pk_bf16_f32 v48, v84, v85
    v_cvt_pk_bf16_f32 v49, v86, v87
    v_cvt_pk_bf16_f32 v50, v80, v81
    v_cvt_pk_bf16_f32 v51, v82, v83
    s_nop 0
    s_nop 0
    v_mfma_f32_16x16x32_bf16 v[72:75], v[48:51], v[22:25], 0
    v_mfma_f32_16x16x32_bf16 v[76:79], v[48:51], v[20:23], 0
    v_mfma_f32_16x16x32_bf16 v[64:67], v[48:51], v[10:13], 0
    v_mfma_f32_16x16x32_bf16 v[68:71], v[48:51], v[8:11], 0
    v_pk_mul_f32 v[88:89], v[108:109], v[124:125]
    v_pk_mul_f32 v[92:93], v[104:105], v[124:125]
    v_pk_mul_f32 v[90:91], v[110:111], v[126:127]
    v_pk_mul_f32 v[94:95], v[106:107], v[126:127]
    v_pk_fma_f32 v[88:89], v[104:105], v[116:117], v[88:89] neg_lo:[0,0,1] neg_hi:[0,0,1]
    v_pk_fma_f32 v[92:93], v[108:109], v[116:117], v[92:93]
    v_pk_fma_f32 v[90:91], v[106:107], v[118:119], v[90:91] neg_lo:[0,0,1] neg_hi:[0,0,1]
    v_pk_fma_f32 v[94:95], v[110:111], v[118:119], v[94:95]
    v_cvt_pk_bf16_f32 v52, v92, v93
    v_cvt_pk_bf16_f32 v53, v94, v95
    v_cvt_pk_bf16_f32 v54, v88, v89
    v_cvt_pk_bf16_f32 v55, v90, v91
    s_nop 1
    v_mfma_f32_16x16x32_bf16 v[72:75], v[52:55], v[28:31], v[72:75]
    v_mfma_f32_16x16x32_bf16 v[76:79], v[52:55], v[26:29], v[76:79]
    v_mfma_f32_16x16x32_bf16 v[64:67], v[52:55], v[16:19], v[64:67]
    v_mfma_f32_16x16x32_bf16 v[68:71], v[52:55], v[14:17], v[68:71]
    buffer_load_dwordx2 v[252:253], v132, s[12:15], s61 offen sc1
    s_nop 3
    v_pk_mul_f32 v[88:89], v[72:73], v[172:173]
    v_pk_mul_f32 v[92:93], v[76:77], v[172:173]
    v_pk_mul_f32 v[90:91], v[74:75], v[174:175]
    v_pk_mul_f32 v[94:95], v[78:79], v[174:175]
    v_pk_fma_f32 v[88:89], v[76:77], v[168:169], v[88:89] neg_lo:[0,0,1] neg_hi:[0,0,1]
    v_pk_fma_f32 v[92:93], v[72:73], v[168:169], v[92:93]
    v_pk_fma_f32 v[90:91], v[78:79], v[170:171], v[90:91] neg_lo:[0,0,1] neg_hi:[0,0,1]
    v_pk_fma_f32 v[94:95], v[74:75], v[170:171], v[94:95]
    v_cvt_pk_bf16_f32 v56, v92, v93
    v_cvt_pk_bf16_f32 v57, v94, v95
    v_cvt_pk_bf16_f32 v58, v88, v89
    v_cvt_pk_bf16_f32 v59, v90, v91
    ds_write_b128 v188, v[56:59]
    v_pk_mul_f32 v[80:81], v[64:65], v[160:161]
    v_pk_mul_f32 v[84:85], v[68:69], v[160:161]
    v_pk_mul_f32 v[82:83], v[66:67], v[162:163]
    v_pk_mul_f32 v[86:87], v[70:71], v[162:163]
    v_pk_fma_f32 v[80:81], v[68:69], v[152:153], v[80:81] neg_lo:[0,0,1] neg_hi:[0,0,1]
    v_pk_fma_f32 v[84:85], v[64:65], v[152:153], v[84:85]
    v_pk_fma_f32 v[82:83], v[70:71], v[154:155], v[82:83] neg_lo:[0,0,1] neg_hi:[0,0,1]
    v_pk_fma_f32 v[86:87], v[66:67], v[154:155], v[86:87]
    v_cvt_pk_bf16_f32 v48, v84, v85
    v_cvt_pk_bf16_f32 v49, v86, v87
    v_cvt_pk_bf16_f32 v50, v80, v81
    v_cvt_pk_bf16_f32 v51, v82, v83
    s_waitcnt lgkmcnt(0)
    s_barrier
    ds_read_b128 v[56:59], v189
    v_mfma_f32_16x16x32_bf16 v[96:99], v[10:13], v[48:51], 0
    v_mfma_f32_16x16x32_bf16 v[100:103], v[8:11], v[48:51], 0
    v_mfma_f32_16x16x32_bf16 v[104:107], v[22:25], v[48:51], 0
    v_mfma_f32_16x16x32_bf16 v[108:111], v[20:23], v[48:51], 0
    v_lshrrev_b32 v2, 5, v0
    v_lshlrev_b32 v2, 9, v2
    v_bfe_u32 v3, v0, 2, 2
    v_lshl_add_u32 v2, v3, 6, v2
    v_bfe_u32 v3, v0, 4, 1
    v_lshl_add_u32 v2, v3, 5, v2
    v_and_b32_e64 v3, 3, v0
    v_lshl_add_u32 v2, v3, 3, v2
    v_add_u32 v3, 0x10000, v2
    s_waitcnt lgkmcnt(0)
    v_mfma_f32_16x16x32_bf16 v[96:99], v[16:19], v[56:59], v[96:99]
    v_mfma_f32_16x16x32_bf16 v[100:103], v[14:17], v[56:59], v[100:103]
    v_mfma_f32_16x16x32_bf16 v[104:107], v[28:31], v[56:59], v[104:107]
    v_mfma_f32_16x16x32_bf16 v[108:111], v[26:29], v[56:59], v[108:111]
    s_nop 5
    v_cvt_pk_bf16_f32 v48, v100, v96
    v_cvt_pk_bf16_f32 v49, v101, v97
    v_cvt_pk_bf16_f32 v50, v102, v98
    v_cvt_pk_bf16_f32 v51, v103, v99
    ds_write_b128 v184, v[48:51]
    v_cvt_pk_bf16_f32 v52, v108, v104
    v_cvt_pk_bf16_f32 v53, v109, v105
    v_cvt_pk_bf16_f32 v54, v110, v106
    v_cvt_pk_bf16_f32 v55, v111, v107
    ds_write_b128 v186, v[52:55]
    v_mov_b32 v5, v132
    s_waitcnt vmcnt(0)
    v_cmp_ne_u64 vcc, s[42:43], v[252:253]
    s_nop 0
    s_cmp_lg_u64 vcc, 0
    s_cbranch_scc1 Lpa31
Lpd32:
    s_mov_b64 exec, 1
    buffer_store_dwordx2 v[250:251], v249, s[12:15], s60 offen offset:128 sc1
    s_mov_b64 exec, -1
    buffer_load_dwordx4 v[140:143], v1, s[12:15], s20 offen offset:0 sc1
    buffer_load_dwordx4 v[144:147], v1, s[12:15], s20 offen offset:1024 sc1
    buffer_load_dwordx4 v[148:151], v1, s[12:15], s21 offen offset:0 sc1
    buffer_load_dwordx4 v[208:211], v1, s[12:15], s21 offen offset:1024 sc1
    buffer_load_dwordx4 v[212:215], v1, s[12:15], s22 offen offset:0 sc1
    buffer_load_dwordx4 v[216:219], v1, s[12:15], s22 offen offset:1024 sc1
    buffer_load_dwordx4 v[220:223], v1, s[12:15], s23 offen offset:0 sc1
    buffer_load_dwordx4 v[224:227], v1, s[12:15], s23 offen offset:1024 sc1
    s_waitcnt lgkmcnt(0)
    s_barrier
    ds_read_b64 v[64:65], v190 offset:0
    ds_read_b64 v[68:69], v190 offset:4096
    ds_read_b64 v[66:67], v190 offset:512
    ds_read_b64 v[70:71], v190 offset:4608
    s_waitcnt lgkmcnt(0)
    s_nop 0
    ds_read_b64_tr_b16 v[32:33], v2 offset:0
    ds_read_b64_tr_b16 v[34:35], v2 offset:1024
    ds_read_b64_tr_b16 v[36:37], v2 offset:256
    ds_read_b64_tr_b16 v[38:39], v2 offset:1280
    ds_read_b64_tr_b16 v[40:41], v2 offset:2048
    ds_read_b64_tr_b16 v[42:43], v2 offset:3072
    ds_read_b64_tr_b16 v[44:45], v2 offset:2304
    ds_read_b64_tr_b16 v[46:47], v2 offset:3328
    ds_read_b64_tr_b16 v[48:49], v2 offset:8192
    ds_read_b64_tr_b16 v[50:51], v2 offset:9216
    ds_read_b64_tr_b16 v[52:53], v2 offset:8448
    ds_read_b64_tr_b16 v[54:55], v2 offset:9472
    ds_read_b64_tr_b16 v[56:57], v2 offset:10240
    ds_read_b64_tr_b16 v[58:59], v2 offset:11264
    v_dot2_f32_bf16 v88, v64, s56, 0 neg_hi:[0,1,0]
    v_dot2_f32_bf16 v92, v64, s56, 0
    v_dot2_f32_bf16 v89, v65, s56, 0 neg_hi:[0,1,0]
    v_dot2_f32_bf16 v93, v65, s56, 0
    v_dot2_f32_bf16 v90, v66, s56, 0 neg_hi:[0,1,0]
    v_dot2_f32_bf16 v94, v66, s56, 0
    v_dot2_f32_bf16 v91, v67, s56, 0 neg_hi:[0,1,0]
    v_dot2_f32_bf16 v95, v67, s56, 0
    v_dot2_f32_bf16 v72, v68, v176, v88
    v_dot2_f32_bf16 v73, v68, v180, v92 neg_lo:[0,1,0]
    v_dot2_f32_bf16 v74, v68, v180, v92 neg_hi:[0,1,0]
    v_dot2_f32_bf16 v75, v68, v176, v88 neg_lo:[0,1,0] neg_hi:[0,1,0]
    v_dot2_f32_bf16 v76, v69, v177, v89
    v_dot2_f32_bf16 v77, v69, v181, v93 neg_lo:[0,1,0]
    v_dot2_f32_bf16 v78, v69, v181, v93 neg_hi:[0,1,0]
    v_dot2_f32_bf16 v79, v69, v177, v89 neg_lo:[0,1,0] neg_hi:[0,1,0]
    v_dot2_f32_bf16 v80, v70, v178, v90
    v_dot2_f32_bf16 v81, v70, v182, v94 neg_lo:[0,1,0]
    v_dot2_f32_bf16 v82, v70, v182, v94 neg_hi:[0,1,0]
    v_dot2_f32_bf16 v83, v70, v178, v90 neg_lo:[0,1,0] neg_hi:[0,1,0]
    v_dot2_f32_bf16 v84, v71, v179, v91
    v_dot2_f32_bf16 v85, v71, v183, v95 neg_lo:[0,1,0]
    v_dot2_f32_bf16 v86, v71, v183, v95 neg_hi:[0,1,0]
    v_dot2_f32_bf16 v87, v71, v179, v91 neg_lo:[0,1,0] neg_hi:[0,1,0]
    ds_read_b64_tr_b16 v[60:61], v2 offset:10496
    ds_read_b64_tr_b16 v[62:63], v2 offset:11520
    s_cmp_eq_u32 s51, 0
    s_cbranch_scc1 Lk0
Lnk0:
    v_cvt_pk_bf16_f32 v96, v72, v73
    v_cvt_pk_bf16_f32 v97, v74, v75
    v_cvt_pk_bf16_f32 v98, v76, v77
    v_cvt_pk_bf16_f32 v99, v78, v79
    v_cvt_pk_bf16_f32 v100, v80, v81
    v_cvt_pk_bf16_f32 v101, v82, v83
    v_cvt_pk_bf16_f32 v102, v84, v85
    v_cvt_pk_bf16_f32 v103, v86, v87
    buffer_store_dwordx4 v[96:99], v130, s[12:15], s66 offen sc1
    buffer_store_dwordx4 v[100:103], v130, s[12:15], s66 offen offset:2048 sc1
    buffer_load_dwordx4 v[228:231], v1, s[12:15], s24 offen offset:0 sc1
    buffer_load_dwordx4 v[232:235], v1, s[12:15], s24 offen offset:1024 sc1
    buffer_load_dwordx4 v[236:239], v1, s[12:15], s25 offen offset:0 sc1
    buffer_load_dwordx4 v[240:243], v1, s[12:15], s25 offen offset:1024 sc1
    buffer_load_dwordx4 v[244:247], v1, s[12:15], s26 offen offset:0 sc1
    s_add_u32 s61, s61, 128
    s_lshl_b32 s60, s46, 11
    s_lshl_b32 s53, s51, 3
    s_add_u32 s60, s60, s53
    s_add_u32 s60, s60, 24576
    s_waitcnt vmcnt(14) lgkmcnt(14)
    v_mfma_f32_32x32x16_bf16 v[64:79], v[32:35], v[140:143], 0
    ds_read2_b32 v[128:129], v254 offset0:64 offset1:128
    ds_read_b64_tr_b16 v[32:33], v2 offset:16384
    ds_read_b64_tr_b16 v[34:35], v2 offset:17408
    buffer_load_dwordx4 v[152:155], v1, s[12:15], s26 offen offset:1024 sc1
    s_lshr_b32 s65, s50, 7
    s_lshl_b32 s65, s65, 1
    s_waitcnt lgkmcnt(14)
    v_mfma_f32_32x32x16_bf16 v[80:95], v[36:39], v[140:143], 0
    ds_read_b64_tr_b16 v[36:37], v2 offset:16640
    ds_read_b64_tr_b16 v[38:39], v2 offset:17664
    s_bfe_u32 s53, s50, 0x10004
    s_add_u32 s65, s65, s53
    s_waitcnt vmcnt(14) lgkmcnt(14)
    v_mfma_f32_32x32x16_bf16 v[64:79], v[40:43], v[144:147], v[64:79]
    ds_read_b64_tr_b16 v[40:41], v2 offset:18432
    ds_read_b64_tr_b16 v[42:43], v2 offset:19456
    buffer_load_dwordx4 v[156:159], v1, s[12:15], s27 offen offset:0 sc1
    s_lshl_b32 s65, s65, 11
    s_lshl_b32 s53, s46, 9
    s_waitcnt lgkmcnt(14)
    v_mfma_f32_32x32x16_bf16 v[80:95], v[44:47], v[144:147], v[80:95]
    ds_read_b64_tr_b16 v[44:45], v2 offset:18688
    ds_read_b64_tr_b16 v[46:47], v2 offset:19712
    s_add_u32 s65, s65, s53
    s_add_u32 s65, s65, 24576
    s_waitcnt vmcnt(14) lgkmcnt(14)
    v_mfma_f32_32x32x16_bf16 v[64:79], v[48:51], v[148:151], v[64:79]
    ds_read_b64_tr_b16 v[48:49], v2 offset:24576
    ds_read_b64_tr_b16 v[50:51], v2 offset:25600
    buffer_load_dwordx4 v[160:163], v1, s[12:15], s27 offen offset:1024 sc1
    v_lshlrev_b32 v7, 3, v0
    s_mul_i32 s66, s46, 532480
    s_waitcnt lgkmcnt(14)
    v_mfma_f32_32x32x16_bf16 v[80:95], v[52:55], v[148:151], v[80:95]
    ds_read_b64_tr_b16 v[52:53], v2 offset:24832
    ds_read_b64_tr_b16 v[54:55], v2 offset:25856
    s_lshl_b32 s53, s50, 5
    s_add_u32 s66, s66, s53
    s_waitcnt vmcnt(14) lgkmcnt(14)
    v_mfma_f32_32x32x16_bf16 v[64:79], v[56:59], v[208:211], v[64:79]
    ds_read_b64_tr_b16 v[56:57], v2 offset:26624
    ds_read_b64_tr_b16 v[58:59], v2 offset:27648
    buffer_load_dwordx4 v[140:143], v1, s[12:15], s28 offen offset:0 sc1
    s_add_u32 s66, s66, 5767168
    s_add_u32 s67, s66, 266240
    s_waitcnt lgkmcnt(14)
    v_mfma_f32_32x32x16_bf16 v[80:95], v[60:63], v[208:211], v[80:95]
    ds_read_b64_tr_b16 v[60:61], v2 offset:26880
    ds_read_b64_tr_b16 v[62:63], v2 offset:27904
    s_lshl_b32 s68, s46, 3
    s_add_u32 s68, s68, 147456
    s_waitcnt lgkmcnt(14)
    v_min_u32 v128, v128, v129
    s_nop 0
    v_readfirstlane_b32 s58, v128
    s_nop 0
    s_cmp_lt_u32 s58, 11
    s_cbranch_scc1 Lcs33
Lcb34:
    s_waitcnt vmcnt(14) lgkmcnt(14)
    v_mfma_f32_32x32x16_bf16 v[64:79], v[32:35], v[212:215], v[64:79]
    ds_read_b64_tr_b16 v[32:33], v2 offset:32768
    ds_read_b64_tr_b16 v[34:35], v2 offset:33792
    buffer_load_dwordx4 v[144:147], v1, s[12:15], s28 offen offset:1024 sc1
    s_mov_b32 s69, 0x35000000
    s_lshl_b32 s36, s59, 5
    s_waitcnt lgkmcnt(14)
    v_mfma_f32_32x32x16_bf16 v[80:95], v[36:39], v[212:215], v[80:95]
    ds_read_b64_tr_b16 v[36:37], v2 offset:33024
    ds_read_b64_tr_b16 v[38:39], v2 offset:34048
    buffer_load_dwordx2 v[252:253], v5, s[12:15], s61 offen sc1
    s_lshl_b32 s37, s46, 11
    s_add_u32 s38, s37, 131072
    s_waitcnt vmcnt(15) lgkmcnt(14)
    v_mfma_f32_32x32x16_bf16 v[64:79], v[40:43], v[216:219], v[64:79]
    ds_read_b64_tr_b16 v[40:41], v2 offset:34816
    ds_read_b64_tr_b16 v[42:43], v2 offset:35840
    buffer_load_dwordx4 v[148:151], v1, s[12:15], s29 offen offset:0 sc1
    s_add_u32 s37, s37, 147456
    s_mov_b32 s8, s34
    s_waitcnt lgkmcnt(14)
    v_mfma_f32_32x32x16_bf16 v[80:95], v[44:47], v[216:219], v[80:95]
    ds_read_b64_tr_b16 v[44:45], v2 offset:35072
    ds_read_b64_tr_b16 v[46:47], v2 offset:36096
    s_mov_b32 s9, s35
    s_mov_b32 s10, 1024
    s_waitcnt vmcnt(15) lgkmcnt(14)
    v_mfma_f32_32x32x16_bf16 v[64:79], v[48:51], v[220:223], v[64:79]
    ds_read_b64_tr_b16 v[48:49], v2 offset:40960
    ds_read_b64_tr_b16 v[50:51], v2 offset:41984
    buffer_load_dwordx4 v[208:211], v1, s[12:15], s29 offen offset:1024 sc1
    v_and_b32 v196, 15, v0
    v_lshrrev_b32 v197, 4, v0
    s_waitcnt lgkmcnt(14)
    v_mfma_f32_32x32x16_bf16 v[80:95], v[52:55], v[220:223], v[80:95]
    ds_read_b64_tr_b16 v[52:53], v2 offset:41216
    ds_read_b64_tr_b16 v[54:55], v2 offset:42240
    v_lshlrev_b32 v197, 2, v197
    v_add_u32 v112, s59, v197
    s_waitcnt vmcnt(15) lgkmcnt(14)
    v_mfma_f32_32x32x16_bf16 v[64:79], v[56:59], v[224:227], v[64:79]
    ds_read_b64_tr_b16 v[56:57], v2 offset:43008
    ds_read_b64_tr_b16 v[58:59], v2 offset:44032
    buffer_load_dwordx4 v[212:215], v1, s[12:15], s30 offen offset:0 sc1
    v_xor_b32 v113, 16, v112
    v_cvt_f32_u32 v104, v112
    s_waitcnt lgkmcnt(14)
    v_mfma_f32_32x32x16_bf16 v[80:95], v[60:63], v[224:227], v[80:95]
    ds_read_b64_tr_b16 v[60:61], v2 offset:43264
    ds_read_b64_tr_b16 v[62:63], v2 offset:44288
    v_cvt_f32_u32 v108, v113
    v_add_f32 v105, 1.0, v104
    s_waitcnt vmcnt(13) lgkmcnt(14)
    v_mfma_f32_32x32x16_bf16 v[64:79], v[32:35], v[228:231], v[64:79]
    ds_read_b64_tr_b16 v[32:33], v2 offset:49152
    ds_read_b64_tr_b16 v[34:35], v2 offset:50176
    s_mov_b64 exec, 1
    buffer_store_dwordx2 v[250:251], v249, s[12:15], s60 offen offset:0 sc1
    s_mov_b64 exec, -1
    buffer_load_dwordx4 v[216:219], v1, s[12:15], s30 offen offset:1024 sc1
    v_add_f32 v106, 2.0, v104
    v_add_f32 v107, 1.0, v106
    s_waitcnt lgkmcnt(14)
    v_mfma_f32_32x32x16_bf16 v[80:95], v[36:39], v[228:231], v[80:95]
    ds_read_b64_tr_b16 v[36:37], v2 offset:49408
    ds_read_b64_tr_b16 v[38:39], v2 offset:50432
    v_add_f32 v109, 1.0, v108
    v_add_f32 v110, 2.0, v108
    s_waitcnt vmcnt(14) lgkmcnt(14)
    v_mfma_f32_32x32x16_bf16 v[64:79], v[40:43], v[232:235], v[64:79]
    ds_read_b64_tr_b16 v[40:41], v2 offset:51200
    ds_read_b64_tr_b16 v[42:43], v2 offset:52224
    buffer_load_dwordx4 v[220:223], v1, s[12:15], s31 offen offset:0 sc1
    v_add_f32 v111, 1.0, v110
    v_lshrrev_b32 v200, 1, v0
    s_waitcnt lgkmcnt(14)
    v_mfma_f32_32x32x16_bf16 v[80:95], v[44:47], v[232:235], v[80:95]
    ds_read_b64_tr_b16 v[44:45], v2 offset:51456
    ds_read_b64_tr_b16 v[46:47], v2 offset:52480
    v_mul_u32_u24 v200, 8320, v200
    v_and_b32 v112, 1, v0
    s_waitcnt vmcnt(14) lgkmcnt(14)
    v_mfma_f32_32x32x16_bf16 v[64:79], v[48:51], v[236:239], v[64:79]
    ds_read_b64_tr_b16 v[48:49], v2 offset:57344
    ds_read_b64_tr_b16 v[50:51], v2 offset:58368
    buffer_load_dwordx4 v[224:227], v1, s[12:15], s31 offen offset:1024 sc1
    v_lshl_add_u32 v200, v112, 4, v200
    v_lshlrev_b32 v198, 5, v196
    s_waitcnt lgkmcnt(14)
    v_mfma_f32_32x32x16_bf16 v[80:95], v[52:55], v[236:239], v[80:95]
    ds_read_b64_tr_b16 v[52:53], v2 offset:57600
    ds_read_b64_tr_b16 v[54:55], v2 offset:58624
    v_lshl_add_u32 v198, v197, 1, v198
    v_add_u32 v198, s36, v198
    s_waitcnt vmcnt(14) lgkmcnt(14)
    v_mfma_f32_32x32x16_bf16 v[64:79], v[56:59], v[240:243], v[64:79]
    ds_read_b64_tr_b16 v[56:57], v2 offset:59392
    ds_read_b64_tr_b16 v[58:59], v2 offset:60416
    buffer_load_dwordx4 v[228:231], v1, s[12:15], s32 offen offset:0 sc1
    v_xor_b32 v199, 512, v198
    v_add_u32 v201, s37, v1
    s_waitcnt lgkmcnt(14)
    v_mfma_f32_32x32x16_bf16 v[80:95], v[60:63], v[240:243], v[80:95]
    ds_read_b64_tr_b16 v[60:61], v2 offset:59648
    ds_read_b64_tr_b16 v[62:63], v2 offset:60672
    v_add_u32 v202, s38, v198
    v_add_u32 v203, s38, v199
    s_waitcnt vmcnt(14) lgkmcnt(14)
    v_mfma_f32_32x32x16_bf16 v[64:79], v[32:35], v[244:247], v[64:79]
    ds_read_b64_tr_b16 v[32:33], v3 offset:0
    ds_read_b64_tr_b16 v[34:35], v3 offset:1024
    buffer_load_dwordx4 v[232:235], v1, s[12:15], s32 offen offset:1024 sc1
    v_add_u32 v112, s59, v196
    v_lshl_add_u32 v112, v197, 5, v112
    s_waitcnt lgkmcnt(14)
    v_mfma_f32_32x32x16_bf16 v[80:95], v[36:39], v[244:247], v[80:95]
    ds_read_b64_tr_b16 v[36:37], v3 offset:256
    ds_read_b64_tr_b16 v[38:39], v3 offset:1280
    v_xor_b32 v113, 16, v112
    v_lshrrev_b32 v115, 5, v0
    s_waitcnt vmcnt(14) lgkmcnt(14)
    v_mfma_f32_32x32x16_bf16 v[64:79], v[40:43], v[152:155], v[64:79]
    ds_read_b64_tr_b16 v[40:41], v3 offset:2048
    ds_read_b64_tr_b16 v[42:43], v3 offset:3072
    buffer_load_dwordx4 v[236:239], v1, s[12:15], s33 offen offset:0 sc1
    v_lshlrev_b32 v114, 6, v115
    v_sub_u32 v114, 32, v114
    s_waitcnt lgkmcnt(14)
    v_mfma_f32_32x32x16_bf16 v[80:95], v[44:47], v[152:155], v[80:95]
    ds_read_b64_tr_b16 v[44:45], v3 offset:2304
    ds_read_b64_tr_b16 v[46:47], v3 offset:3328
    v_mul_u32_u24 v115, 0x4004, v115
    v_mad_i32_i24 v164, v112, v114, v115
    s_waitcnt vmcnt(14) lgkmcnt(14)
    v_mfma_f32_32x32x16_bf16 v[64:79], v[48:51], v[156:159], v[64:79]
    ds_read_b64_tr_b16 v[48:49], v3 offset:8192
    ds_read_b64_tr_b16 v[50:51], v3 offset:9216
    buffer_load_dwordx4 v[240:243], v1, s[12:15], s33 offen offset:1024 sc1
    v_mad_i32_i24 v168, v113, v114, v115
    v_lshlrev_b32 v114, 5, v114
    s_waitcnt lgkmcnt(14)
    v_mfma_f32_32x32x16_bf16 v[80:95], v[52:55], v[156:159], v[80:95]
    ds_read_b64_tr_b16 v[52:53], v3 offset:8448
    ds_read_b64_tr_b16 v[54:55], v3 offset:9472
    v_add3_u32 v165, v164, v114, s68
    v_add3_u32 v169, v168, v114, s68
    s_waitcnt vmcnt(14) lgkmcnt(14)
    v_mfma_f32_32x32x16_bf16 v[64:79], v[56:59], v[160:163], v[64:79]
    ds_read_b64_tr_b16 v[56:57], v3 offset:10240
    ds_read_b64_tr_b16 v[58:59], v3 offset:11264
    s_waitcnt vmcnt(11)
    v_cmp_ne_u64 vcc, s[42:43], v[252:253]
    s_nop 0
    s_cmp_lg_u64 vcc, 0
    s_cbranch_scc1 Lpa35
Lpd36:
    buffer_load_dwordx4 v[244:247], v1, s[12:15], s20 offen offset:2048 sc1
    v_add_u32 v166, v165, v114
    v_add_u32 v167, v166, v114
    s_waitcnt lgkmcnt(14)
    v_mfma_f32_32x32x16_bf16 v[80:95], v[60:63], v[160:163], v[80:95]
    ds_read_b64_tr_b16 v[60:61], v3 offset:10496
    ds_read_b64_tr_b16 v[62:63], v3 offset:11520
    v_add_u32 v170, v169, v114
    v_add_u32 v171, v170, v114
    s_waitcnt vmcnt(14) lgkmcnt(14)
    v_mfma_f32_32x32x16_bf16 v[64:79], v[32:35], v[140:143], v[64:79]
    ds_read_b64_tr_b16 v[32:33], v3 offset:16384
    ds_read_b64_tr_b16 v[34:35], v3 offset:17408
    buffer_load_dwordx4 v[152:155], v1, s[12:15], s20 offen offset:3072 sc1
    v_and_b32 v164, 0x1fff, v164
    v_and_b32 v168, 0x1fff, v168
    s_waitcnt lgkmcnt(14)
    v_mfma_f32_32x32x16_bf16 v[80:95], v[36:39], v[140:143], v[80:95]
    ds_read_b64_tr_b16 v[36:37], v3 offset:16640
    ds_read_b64_tr_b16 v[38:39], v3 offset:17664
    v_add_u32 v164, s68, v164
    v_add_u32 v168, s68, v168
    s_waitcnt vmcnt(14) lgkmcnt(14)
    v_mfma_f32_32x32x16_bf16 v[64:79], v[40:43], v[144:147], v[64:79]
    ds_read_b64_tr_b16 v[40:41], v3 offset:18432
    ds_read_b64_tr_b16 v[42:43], v3 offset:19456
    buffer_load_dwordx4 v[156:159], v1, s[12:15], s21 offen offset:2048 sc1
    v_cvt_f32_u32 v120, v197
    v_add_f32 v121, 1.0, v120
    s_waitcnt lgkmcnt(14)
    v_mfma_f32_32x32x16_bf16 v[80:95], v[44:47], v[144:147], v[80:95]
    ds_read_b64_tr_b16 v[44:45], v3 offset:18688
    ds_read_b64_tr_b16 v[46:47], v3 offset:19712
    v_add_f32 v122, 2.0, v120
    v_add_f32 v123, 1.0, v122
    s_waitcnt vmcnt(13) lgkmcnt(14)
    v_mfma_f32_32x32x16_bf16 v[64:79], v[48:51], v[148:151], v[64:79]
    ds_read_b64_tr_b16 v[48:49], v3 offset:24576
    ds_read_b64_tr_b16 v[50:51], v3 offset:25600
    buffer_load_dwordx4 v[160:163], v1, s[12:15], s21 offen offset:3072 sc1
    v_cvt_f32_u32 v124, v196
    v_mul_f32 v125, 0x3d800000, v124
    s_waitcnt lgkmcnt(14)
    v_mfma_f32_32x32x16_bf16 v[80:95], v[52:55], v[148:151], v[80:95]
    ds_read_b64_tr_b16 v[52:53], v3 offset:24832
    ds_read_b64_tr_b16 v[54:55], v3 offset:25856
    v_mul_f32 v116, v125, v120
    v_mul_f32 v117, v125, v121
    s_waitcnt vmcnt(13) lgkmcnt(14)
    v_mfma_f32_32x32x16_bf16 v[64:79], v[56:59], v[208:211], v[64:79]
    ds_read_b64_tr_b16 v[56:57], v3 offset:26624
    ds_read_b64_tr_b16 v[58:59], v3 offset:27648
    buffer_load_dwordx4 v[140:143], v1, s[12:15], s22 offen offset:2048 sc1
    v_mul_f32 v118, v125, v122
    v_mul_f32 v119, v125, v123
    s_waitcnt lgkmcnt(14)
    v_mfma_f32_32x32x16_bf16 v[80:95], v[60:63], v[208:211], v[80:95]
    ds_read_b64_tr_b16 v[60:61], v3 offset:26880
    ds_read_b64_tr_b16 v[62:63], v3 offset:27904
    v_cos_f32 v112, v116
    v_cos_f32 v113, v117
    s_waitcnt vmcnt(13) lgkmcnt(14)
    v_mfma_f32_32x32x16_bf16 v[64:79], v[32:35], v[212:215], v[64:79]
    ds_read_b64_tr_b16 v[32:33], v3 offset:32768
    ds_read_b64_tr_b16 v[34:35], v3 offset:33792
    buffer_load_dwordx4 v[144:147], v1, s[12:15], s22 offen offset:3072 sc1
    v_cos_f32 v114, v118
    v_cos_f32 v115, v119
    s_waitcnt lgkmcnt(14)
    v_mfma_f32_32x32x16_bf16 v[80:95], v[36:39], v[212:215], v[80:95]
    ds_read_b64_tr_b16 v[36:37], v3 offset:33024
    ds_read_b64_tr_b16 v[38:39], v3 offset:34048
    v_sin_f32 v116, v116
    v_sin_f32 v117, v117
    s_waitcnt vmcnt(12) lgkmcnt(14)
    v_mfma_f32_32x32x16_bf16 v[64:79], v[40:43], v[216:219], v[64:79]
    ds_read_b64_tr_b16 v[40:41], v3 offset:34816
    ds_read_b64_tr_b16 v[42:43], v3 offset:35840
    buffer_load_dwordx4 v[148:151], v1, s[12:15], s23 offen offset:2048 sc1
    v_sin_f32 v118, v118
    v_sin_f32 v119, v119
    s_waitcnt lgkmcnt(14)
    v_mfma_f32_32x32x16_bf16 v[80:95], v[44:47], v[216:219], v[80:95]
    ds_read_b64_tr_b16 v[44:45], v3 offset:35072
    ds_read_b64_tr_b16 v[46:47], v3 offset:36096
    v_mul_f32 v125, 0x3b000000, v124
    v_cvt_pk_bf16_f32 v172, v112, -v116
    s_waitcnt vmcnt(12) lgkmcnt(14)
    v_mfma_f32_32x32x16_bf16 v[64:79], v[48:51], v[220:223], v[64:79]
    ds_read_b64_tr_b16 v[48:49], v3 offset:40960
    ds_read_b64_tr_b16 v[50:51], v3 offset:41984
    buffer_load_dwordx4 v[208:211], v1, s[12:15], s23 offen offset:3072 sc1
    v_cvt_pk_bf16_f32 v176, v116, v112
    v_cvt_pk_bf16_f32 v173, v113, -v117
    s_waitcnt lgkmcnt(14)
    v_mfma_f32_32x32x16_bf16 v[80:95], v[52:55], v[220:223], v[80:95]
    ds_read_b64_tr_b16 v[52:53], v3 offset:41216
    ds_read_b64_tr_b16 v[54:55], v3 offset:42240
    v_cvt_pk_bf16_f32 v177, v117, v113
    v_cvt_pk_bf16_f32 v174, v114, -v118
    s_waitcnt vmcnt(12) lgkmcnt(14)
    v_mfma_f32_32x32x16_bf16 v[64:79], v[56:59], v[224:227], v[64:79]
    ds_read_b64_tr_b16 v[56:57], v3 offset:43008
    ds_read_b64_tr_b16 v[58:59], v3 offset:44032
    buffer_load_dwordx4 v[212:215], v1, s[12:15], s24 offen offset:2048 sc1
    v_cvt_pk_bf16_f32 v178, v118, v114
    v_cvt_pk_bf16_f32 v175, v115, -v119
    s_waitcnt lgkmcnt(14)
    v_mfma_f32_32x32x16_bf16 v[80:95], v[60:63], v[224:227], v[80:95]
    ds_read_b64_tr_b16 v[60:61], v3 offset:43264
    ds_read_b64_tr_b16 v[62:63], v3 offset:44288
    v_cvt_pk_bf16_f32 v179, v119, v115
    v_mul_f32 v188, v125, v104
    s_waitcnt vmcnt(12) lgkmcnt(14)
    v_mfma_f32_32x32x16_bf16 v[64:79], v[32:35], v[228:231], v[64:79]
    ds_read_b64_tr_b16 v[32:33], v2 offset:4096
    ds_read_b64_tr_b16 v[34:35], v2 offset:5120
    buffer_load_dwordx4 v[216:219], v1, s[12:15], s24 offen offset:3072 sc1
    v_mul_f32 v189, v125, v105
    v_mul_f32 v190, v125, v106
    s_waitcnt lgkmcnt(14)
    v_mfma_f32_32x32x16_bf16 v[80:95], v[36:39], v[228:231], v[80:95]
    ds_read_b64_tr_b16 v[36:37], v2 offset:4352
    ds_read_b64_tr_b16 v[38:39], v2 offset:5376
    v_mul_f32 v191, v125, v107
    v_mul_f32 v192, v125, v108
    s_waitcnt vmcnt(12) lgkmcnt(14)
    v_mfma_f32_32x32x16_bf16 v[64:79], v[40:43], v[232:235], v[64:79]
    ds_read_b64_tr_b16 v[40:41], v2 offset:6144
    ds_read_b64_tr_b16 v[42:43], v2 offset:7168
    buffer_load_dwordx4 v[220:223], v1, s[12:15], s25 offen offset:2048 sc1
    v_mul_f32 v193, v125, v109
    v_mul_f32 v194, v125, v110
    s_waitcnt lgkmcnt(14)
    v_mfma_f32_32x32x16_bf16 v[80:95], v[44:47], v[232:235], v[80:95]
    ds_read_b64_tr_b16 v[44:45], v2 offset:6400
    ds_read_b64_tr_b16 v[46:47], v2 offset:7424
    v_mul_f32 v195, v125, v111
    v_cos_f32 v180, v188
    s_waitcnt vmcnt(12) lgkmcnt(14)
    v_mfma_f32_32x32x16_bf16 v[64:79], v[48:51], v[236:239], v[64:79]
    ds_read_b64_tr_b16 v[48:49], v2 offset:12288
    ds_read_b64_tr_b16 v[50:51], v2 offset:13312
    buffer_load_dwordx4 v[224:227], v1, s[12:15], s25 offen offset:3072 sc1
    v_cos_f32 v181, v189
    v_cos_f32 v182, v190
    s_waitcnt lgkmcnt(14)
    v_mfma_f32_32x32x16_bf16 v[80:95], v[52:55], v[236:239], v[80:95]
    ds_read_b64_tr_b16 v[52:53], v2 offset:12544
    ds_read_b64_tr_b16 v[54:55], v2 offset:13568
    v_cos_f32 v183, v191
    v_cos_f32 v184, v192
    s_waitcnt vmcnt(12) lgkmcnt(14)
    v_mfma_f32_32x32x16_bf16 v[64:79], v[56:59], v[240:243], v[64:79]
    ds_read_b64_tr_b16 v[56:57], v2 offset:14336
    ds_read_b64_tr_b16 v[58:59], v2 offset:15360
    buffer_load_dwordx4 v[228:231], v1, s[12:15], s26 offen offset:2048 sc1
    v_cos_f32 v185, v193
    v_cos_f32 v186, v194
    s_waitcnt lgkmcnt(14)
    v_mfma_f32_32x32x16_bf16 v[80:95], v[60:63], v[240:243], v[80:95]
    ds_read_b64_tr_b16 v[60:61], v2 offset:14592
    ds_read_b64_tr_b16 v[62:63], v2 offset:15616
    v_cos_f32 v187, v195
    v_sin_f32 v188, v188
    s_waitcnt vmcnt(12) lgkmcnt(14)
    v_mfma_f32_32x32x16_bf16 v[64:79], v[32:35], v[244:247], v[64:79]
    ds_read_b64_tr_b16 v[32:33], v2 offset:20480
    ds_read_b64_tr_b16 v[34:35], v2 offset:21504
    buffer_load_dwordx4 v[232:235], v1, s[12:15], s26 offen offset:3072 sc1
    v_sin_f32 v189, v189
    v_sin_f32 v190, v190
    s_waitcnt lgkmcnt(14)
    v_mfma_f32_32x32x16_bf16 v[80:95], v[36:39], v[244:247], v[80:95]
    ds_read_b64_tr_b16 v[36:37], v2 offset:20736
    ds_read_b64_tr_b16 v[38:39], v2 offset:21760
    v_sin_f32 v191, v191
    v_sin_f32 v192, v192
    s_waitcnt vmcnt(12) lgkmcnt(14)
    v_mfma_f32_32x32x16_bf16 v[64:79], v[40:43], v[152:155], v[64:79]
    ds_read_b64_tr_b16 v[40:41], v2 offset:22528
    ds_read_b64_tr_b16 v[42:43], v2 offset:23552
    buffer_load_dwordx4 v[236:239], v1, s[12:15], s27 offen offset:2048 sc1
    v_sin_f32 v193, v193
    v_sin_f32 v194, v194
    s_waitcnt lgkmcnt(14)
    v_mfma_f32_32x32x16_bf16 v[80:95], v[44:47], v[152:155], v[80:95]
    ds_read_b64_tr_b16 v[44:45], v2 offset:22784
    ds_read_b64_tr_b16 v[46:47], v2 offset:23808
    v_sin_f32 v195, v195
    v_mul_f32 v180, s69, v180
    s_waitcnt vmcnt(12) lgkmcnt(14)
    v_mfma_f32_32x32x16_bf16 v[64:79], v[48:51], v[156:159], v[64:79]
    ds_read_b64_tr_b16 v[48:49], v2 offset:28672
    ds_read_b64_tr_b16 v[50:51], v2 offset:29696
    buffer_load_dwordx4 v[240:243], v1, s[12:15], s27 offen offset:3072 sc1
    v_mul_f32 v181, s69, v181
    v_mul_f32 v182, s69, v182
    s_waitcnt lgkmcnt(14)
    v_mfma_f32_32x32x16_bf16 v[80:95], v[52:55], v[156:159], v[80:95]
    ds_read_b64_tr_b16 v[52:53], v2 offset:28928
    ds_read_b64_tr_b16 v[54:55], v2 offset:29952
    v_mul_f32 v183, s69, v183
    v_mul_f32 v184, s69, v184
    s_waitcnt vmcnt(12) lgkmcnt(14)
    v_mfma_f32_32x32x16_bf16 v[64:79], v[56:59], v[160:163], v[64:79]
    ds_read_b64_tr_b16 v[56:57], v2 offset:30720
    ds_read_b64_tr_b16 v[58:59], v2 offset:31744
    buffer_load_dwordx4 v[244:247], v1, s[12:15], s28 offen offset:2048 sc1
    v_mul_f32 v185, s69, v185
    v_mul_f32 v186, s69, v186
    s_waitcnt lgkmcnt(14)
    v_mfma_f32_32x32x16_bf16 v[80:95], v[60:63], v[160:163], v[80:95]
    ds_read_b64_tr_b16 v[60:61], v2 offset:30976
    ds_read_b64_tr_b16 v[62:63], v2 offset:32000
    v_mul_f32 v187, s69, v187
    v_mul_f32 v188, s69, v188
    s_waitcnt vmcnt(12) lgkmcnt(14)
    v_mfma_f32_32x32x16_bf16 v[64:79], v[32:35], v[140:143], v[64:79]
    ds_read_b64_tr_b16 v[32:33], v2 offset:36864
    ds_read_b64_tr_b16 v[34:35], v2 offset:37888
    buffer_load_dwordx4 v[152:155], v1, s[12:15], s28 offen offset:3072 sc1
    v_mul_f32 v189, s69, v189
    v_mul_f32 v190, s69, v190
    s_waitcnt lgkmcnt(14)
    v_mfma_f32_32x32x16_bf16 v[80:95], v[36:39], v[140:143], v[80:95]
    ds_read_b64_tr_b16 v[36:37], v2 offset:37120
    ds_read_b64_tr_b16 v[38:39], v2 offset:38144
    v_mul_f32 v191, s69, v191
    v_mul_f32 v192, s69, v192
    s_waitcnt vmcnt(12) lgkmcnt(14)
    v_mfma_f32_32x32x16_bf16 v[64:79], v[40:43], v[144:147], v[64:79]
    ds_read_b64_tr_b16 v[40:41], v2 offset:38912
    ds_read_b64_tr_b16 v[42:43], v2 offset:39936
    buffer_load_dwordx4 v[156:159], v1, s[12:15], s29 offen offset:2048 sc1
    v_mul_f32 v193, s69, v193
    v_mul_f32 v194, s69, v194
    s_waitcnt lgkmcnt(14)
    v_mfma_f32_32x32x16_bf16 v[80:95], v[44:47], v[144:147], v[80:95]
    ds_read_b64_tr_b16 v[44:45], v2 offset:39168
    ds_read_b64_tr_b16 v[46:47], v2 offset:40192
    v_mul_f32 v195, s69, v195
    s_waitcnt vmcnt(12) lgkmcnt(14)
    v_mfma_f32_32x32x16_bf16 v[64:79], v[48:51], v[148:151], v[64:79]
    ds_read_b64_tr_b16 v[48:49], v2 offset:45056
    ds_read_b64_tr_b16 v[50:51], v2 offset:46080
    buffer_load_dwordx4 v[160:163], v1, s[12:15], s29 offen offset:3072 sc1
    s_waitcnt lgkmcnt(14)
    v_mfma_f32_32x32x16_bf16 v[80:95], v[52:55], v[148:151], v[80:95]
    ds_read_b64_tr_b16 v[52:53], v2 offset:45312
    ds_read_b64_tr_b16 v[54:55], v2 offset:46336
    s_waitcnt vmcnt(12) lgkmcnt(14)
    v_mfma_f32_32x32x16_bf16 v[64:79], v[56:59], v[208:211], v[64:79]
    ds_read_b64_tr_b16 v[56:57], v2 offset:47104
    ds_read_b64_tr_b16 v[58:59], v2 offset:48128
    buffer_load_dwordx4 v[140:143], v1, s[12:15], s30 offen offset:2048 sc1
    s_waitcnt lgkmcnt(14)
    v_mfma_f32_32x32x16_bf16 v[80:95], v[60:63], v[208:211], v[80:95]
    ds_read_b64_tr_b16 v[60:61], v2 offset:47360
    ds_read_b64_tr_b16 v[62:63], v2 offset:48384
    s_waitcnt vmcnt(12) lgkmcnt(14)
    v_mfma_f32_32x32x16_bf16 v[64:79], v[32:35], v[212:215], v[64:79]
    ds_read_b64_tr_b16 v[32:33], v2 offset:53248
    ds_read_b64_tr_b16 v[34:35], v2 offset:54272
    buffer_load_dwordx4 v[144:147], v1, s[12:15], s30 offen offset:3072 sc1
    s_waitcnt lgkmcnt(14)
    v_mfma_f32_32x32x16_bf16 v[80:95], v[36:39], v[212:215], v[80:95]
    ds_read_b64_tr_b16 v[36:37], v2 offset:53504
    ds_read_b64_tr_b16 v[38:39], v2 offset:54528
    s_waitcnt vmcnt(12) lgkmcnt(14)
    v_mfma_f32_32x32x16_bf16 v[64:79], v[40:43], v[216:219], v[64:79]
    ds_read_b64_tr_b16 v[40:41], v2 offset:55296
    ds_read_b64_tr_b16 v[42:43], v2 offset:56320
    buffer_load_dwordx4 v[148:151], v1, s[12:15], s31 offen offset:2048 sc1
    s_waitcnt lgkmcnt(14)
    v_mfma_f32_32x32x16_bf16 v[80:95], v[44:47], v[216:219], v[80:95]
    ds_read_b64_tr_b16 v[44:45], v2 offset:55552
    ds_read_b64_tr_b16 v[46:47], v2 offset:56576
    s_waitcnt vmcnt(12) lgkmcnt(14)
    v_mfma_f32_32x32x16_bf16 v[64:79], v[48:51], v[220:223], v[64:79]
    ds_read_b64_tr_b16 v[48:49], v2 offset:61440
    ds_read_b64_tr_b16 v[50:51], v2 offset:62464
    buffer_load_dwordx4 v[208:211], v1, s[12:15], s31 offen offset:3072 sc1
    s_waitcnt lgkmcnt(14)
    v_mfma_f32_32x32x16_bf16 v[80:95], v[52:55], v[220:223], v[80:95]
    ds_read_b64_tr_b16 v[52:53], v2 offset:61696
    ds_read_b64_tr_b16 v[54:55], v2 offset:62720
    s_waitcnt vmcnt(12) lgkmcnt(14)
    v_mfma_f32_32x32x16_bf16 v[64:79], v[56:59], v[224:227], v[64:79]
    ds_read_b64_tr_b16 v[56:57], v2 offset:63488
    ds_read_b64_tr_b16 v[58:59], v2 offset:64512
    buffer_load_dwordx4 v[212:215], v1, s[12:15], s32 offen offset:2048 sc1
    s_waitcnt lgkmcnt(14)
    v_mfma_f32_32x32x16_bf16 v[80:95], v[60:63], v[224:227], v[80:95]
    ds_read_b64_tr_b16 v[60:61], v2 offset:63744
    ds_read_b64_tr_b16 v[62:63], v2 offset:64768
    s_waitcnt vmcnt(12) lgkmcnt(14)
    v_mfma_f32_32x32x16_bf16 v[64:79], v[32:35], v[228:231], v[64:79]
    ds_read_b64_tr_b16 v[32:33], v3 offset:4096
    ds_read_b64_tr_b16 v[34:35], v3 offset:5120
    buffer_load_dwordx4 v[216:219], v1, s[12:15], s32 offen offset:3072 sc1
    s_waitcnt lgkmcnt(14)
    v_mfma_f32_32x32x16_bf16 v[80:95], v[36:39], v[228:231], v[80:95]
    ds_read_b64_tr_b16 v[36:37], v3 offset:4352
    ds_read_b64_tr_b16 v[38:39], v3 offset:5376
    s_waitcnt vmcnt(12) lgkmcnt(14)
    v_mfma_f32_32x32x16_bf16 v[64:79], v[40:43], v[232:235], v[64:79]
    ds_read_b64_tr_b16 v[40:41], v3 offset:6144
    ds_read_b64_tr_b16 v[42:43], v3 offset:7168
    buffer_load_dwordx4 v[220:223], v1, s[12:15], s33 offen offset:2048 sc1
    s_waitcnt lgkmcnt(14)
    v_mfma_f32_32x32x16_bf16 v[80:95], v[44:47], v[232:235], v[80:95]
    ds_read_b64_tr_b16 v[44:45], v3 offset:6400
    ds_read_b64_tr_b16 v[46:47], v3 offset:7424
    s_waitcnt vmcnt(12) lgkmcnt(14)
    v_mfma_f32_32x32x16_bf16 v[64:79], v[48:51], v[236:239], v[64:79]
    ds_read_b64_tr_b16 v[48:49], v3 offset:12288
    ds_read_b64_tr_b16 v[50:51], v3 offset:13312
    buffer_load_dwordx4 v[224:227], v1, s[12:15], s33 offen offset:3072 sc1
    s_waitcnt lgkmcnt(14)
    v_mfma_f32_32x32x16_bf16 v[80:95], v[52:55], v[236:239], v[80:95]
    ds_read_b64_tr_b16 v[52:53], v3 offset:12544
    ds_read_b64_tr_b16 v[54:55], v3 offset:13568
    s_waitcnt vmcnt(12) lgkmcnt(14)
    v_mfma_f32_32x32x16_bf16 v[64:79], v[56:59], v[240:243], v[64:79]
    ds_read_b64_tr_b16 v[56:57], v3 offset:14336
    ds_read_b64_tr_b16 v[58:59], v3 offset:15360
    s_waitcnt lgkmcnt(14)
    v_mfma_f32_32x32x16_bf16 v[80:95], v[60:63], v[240:243], v[80:95]
    ds_read_b64_tr_b16 v[60:61], v3 offset:14592
    ds_read_b64_tr_b16 v[62:63], v3 offset:15616
    buffer_load_dwordx2 v[252:253], v7, s[12:15], s65 offen sc1
    buffer_load_dwordx2 v[96:97], v198, s[8:11], 0 offen
    buffer_load_dwordx2 v[98:99], v199, s[8:11], 0 offen
    s_waitcnt vmcnt(14) lgkmcnt(14)
    v_mfma_f32_32x32x16_bf16 v[64:79], v[32:35], v[244:247], v[64:79]
    ds_read_b64_tr_b16 v[32:33], v3 offset:20480
    ds_read_b64_tr_b16 v[34:35], v3 offset:21504
    s_waitcnt lgkmcnt(14)
    v_mfma_f32_32x32x16_bf16 v[80:95], v[36:39], v[244:247], v[80:95]
    ds_read_b64_tr_b16 v[36:37], v3 offset:20736
    ds_read_b64_tr_b16 v[38:39], v3 offset:21760
    s_waitcnt vmcnt(13) lgkmcnt(14)
    v_mfma_f32_32x32x16_bf16 v[64:79], v[40:43], v[152:155], v[64:79]
    ds_read_b64_tr_b16 v[40:41], v3 offset:22528
    ds_read_b64_tr_b16 v[42:43], v3 offset:23552
    s_waitcnt lgkmcnt(14)
    v_mfma_f32_32x32x16_bf16 v[80:95], v[44:47], v[152:155], v[80:95]
    ds_read_b64_tr_b16 v[44:45], v3 offset:22784
    ds_read_b64_tr_b16 v[46:47], v3 offset:23808
    s_waitcnt vmcnt(12) lgkmcnt(14)
    v_mfma_f32_32x32x16_bf16 v[64:79], v[48:51], v[156:159], v[64:79]
    ds_read_b64_tr_b16 v[48:49], v3 offset:28672
    ds_read_b64_tr_b16 v[50:51], v3 offset:29696
    s_waitcnt lgkmcnt(14)
    v_mfma_f32_32x32x16_bf16 v[80:95], v[52:55], v[156:159], v[80:95]
    ds_read_b64_tr_b16 v[52:53], v3 offset:28928
    ds_read_b64_tr_b16 v[54:55], v3 offset:29952
    s_waitcnt vmcnt(11) lgkmcnt(14)
    v_mfma_f32_32x32x16_bf16 v[64:79], v[56:59], v[160:163], v[64:79]
    ds_read_b64_tr_b16 v[56:57], v3 offset:30720
    ds_read_b64_tr_b16 v[58:59], v3 offset:31744
    s_waitcnt lgkmcnt(14)
    v_mfma_f32_32x32x16_bf16 v[80:95], v[60:63], v[160:163], v[80:95]
    ds_read_b64_tr_b16 v[60:61], v3 offset:30976
    ds_read_b64_tr_b16 v[62:63], v3 offset:32000
    s_waitcnt vmcnt(10) lgkmcnt(14)
    v_mfma_f32_32x32x16_bf16 v[64:79], v[32:35], v[140:143], v[64:79]
    ds_read_b64_tr_b16 v[32:33], v3 offset:36864
    ds_read_b64_tr_b16 v[34:35], v3 offset:37888
    s_waitcnt lgkmcnt(14)
    v_mfma_f32_32x32x16_bf16 v[80:95], v[36:39], v[140:143], v[80:95]
    ds_read_b64_tr_b16 v[36:37], v3 offset:37120
    ds_read_b64_tr_b16 v[38:39], v3 offset:38144
    s_waitcnt vmcnt(9) lgkmcnt(14)
    v_mfma_f32_32x32x16_bf16 v[64:79], v[40:43], v[144:147], v[64:79]
    ds_read_b64_tr_b16 v[40:41], v3 offset:38912
    ds_read_b64_tr_b16 v[42:43], v3 offset:39936
    s_waitcnt lgkmcnt(14)
    v_mfma_f32_32x32x16_bf16 v[80:95], v[44:47], v[144:147], v[80:95]
    ds_read_b64_tr_b16 v[44:45], v3 offset:39168
    ds_read_b64_tr_b16 v[46:47], v3 offset:40192
    s_waitcnt vmcnt(8) lgkmcnt(14)
    v_mfma_f32_32x32x16_bf16 v[64:79], v[48:51], v[148:151], v[64:79]
    ds_read_b64_tr_b16 v[48:49], v3 offset:45056
    ds_read_b64_tr_b16 v[50:51], v3 offset:46080
    s_waitcnt lgkmcnt(14)
    v_mfma_f32_32x32x16_bf16 v[80:95], v[52:55], v[148:151], v[80:95]
    ds_read_b64_tr_b16 v[52:53], v3 offset:45312
    ds_read_b64_tr_b16 v[54:55], v3 offset:46336
    s_waitcnt vmcnt(7) lgkmcnt(14)
    v_mfma_f32_32x32x16_bf16 v[64:79], v[56:59], v[208:211], v[64:79]
    ds_read_b64_tr_b16 v[56:57], v3 offset:47104
    ds_read_b64_tr_b16 v[58:59], v3 offset:48128
    s_waitcnt lgkmcnt(14)
    v_mfma_f32_32x32x16_bf16 v[80:95], v[60:63], v[208:211], v[80:95]
    ds_read_b64_tr_b16 v[60:61], v3 offset:47360
    ds_read_b64_tr_b16 v[62:63], v3 offset:48384
    s_waitcnt vmcnt(6) lgkmcnt(14)
    v_mfma_f32_32x32x16_bf16 v[64:79], v[32:35], v[212:215], v[64:79]
    s_waitcnt lgkmcnt(12)
    v_mfma_f32_32x32x16_bf16 v[80:95], v[36:39], v[212:215], v[80:95]
    s_waitcnt vmcnt(5) lgkmcnt(10)
    v_mfma_f32_32x32x16_bf16 v[64:79], v[40:43], v[216:219], v[64:79]
    s_waitcnt lgkmcnt(8)
    v_mfma_f32_32x32x16_bf16 v[80:95], v[44:47], v[216:219], v[80:95]
    s_waitcnt vmcnt(4) lgkmcnt(6)
    v_mfma_f32_32x32x16_bf16 v[64:79], v[48:51], v[220:223], v[64:79]
    s_waitcnt lgkmcnt(4)
    v_mfma_f32_32x32x16_bf16 v[80:95], v[52:55], v[220:223], v[80:95]
    s_waitcnt vmcnt(3) lgkmcnt(2)
    v_mfma_f32_32x32x16_bf16 v[64:79], v[56:59], v[224:227], v[64:79]
    s_waitcnt lgkmcnt(0)
    v_mfma_f32_32x32x16_bf16 v[80:95], v[60:63], v[224:227], v[80:95]
    s_lshl_b32 s57, s49, 6
    s_add_u32 s57, s57, s63
    s_lshl_b32 s57, s57, 15
    s_xor_b32 s48, s48, 4
    s_lshl_b32 s58, s48, 12
    s_add_u32 s57, s57, s58
    s_add_u32 s57, s57, 16777216
    s_nop 2
    s_nop 0
    v_cvt_pk_bf16_f32 v32, v64, v65
    v_cvt_pk_bf16_f32 v33, v66, v67
    v_cvt_pk_bf16_f32 v34, v68, v69
    v_cvt_pk_bf16_f32 v35, v70, v71
    buffer_store_dwordx4 v[32:35], v1, s[12:15], s57 offen offset:0 sc1
    v_cvt_pk_bf16_f32 v36, v72, v73
    v_cvt_pk_bf16_f32 v37, v74, v75
    v_cvt_pk_bf16_f32 v38, v76, v77
    v_cvt_pk_bf16_f32 v39, v78, v79
    buffer_store_dwordx4 v[36:39], v1, s[12:15], s57 offen offset:1024 sc1
    v_cvt_pk_bf16_f32 v40, v80, v81
    v_cvt_pk_bf16_f32 v41, v82, v83
    v_cvt_pk_bf16_f32 v42, v84, v85
    v_cvt_pk_bf16_f32 v43, v86, v87
    buffer_store_dwordx4 v[40:43], v1, s[12:15], s57 offen offset:2048 sc1
    v_cvt_pk_bf16_f32 v44, v88, v89
    v_cvt_pk_bf16_f32 v45, v90, v91
    v_cvt_pk_bf16_f32 v46, v92, v93
    v_cvt_pk_bf16_f32 v47, v94, v95
    buffer_store_dwordx4 v[44:47], v1, s[12:15], s57 offen offset:3072 sc1
    s_waitcnt vmcnt(6)
    v_cmp_ne_u64 vcc, s[42:43], v[252:253]
    s_nop 0
    s_cmp_lg_u64 vcc, 0
    s_cbranch_scc1 Lpa37
Lpd38:
    buffer_load_dwordx4 v[240:243], v200, s[12:15], s66 offen sc1
    buffer_load_dwordx4 v[244:247], v200, s[12:15], s67 offen sc1
    s_lshl_b32 s60, s63, 7
    s_lshl_b32 s58, s48, 4
    s_add_u32 s60, s60, s58
    s_lshl_b32 s58, s49, 3
    s_add_u32 s60, s60, s58
    s_add_u32 s60, s60, 32768
    s_waitcnt vmcnt(2)
    s_mov_b64 exec, 1
    buffer_store_dwordx2 v[250:251], v249, s[12:15], s60 offen offset:0 sc1
    s_mov_b64 exec, -1
    s_waitcnt vmcnt(1)
    ds_write_b128 v201, v[240:243]
    ds_write_b128 v201, v[244:247] offset:1024
    ds_read_b64 v[136:137], v202 offset:0
    ds_read_b64 v[138:139], v202 offset:1024
    ds_read_b64 v[140:141], v203 offset:0
    ds_read_b64 v[142:143], v203 offset:1024
    v_lshlrev_b32 v120, 16, v96
    v_and_b32 v121, 0xffff0000, v96
    v_lshlrev_b32 v122, 16, v97
    v_and_b32 v123, 0xffff0000, v97
    v_lshlrev_b32 v124, 16, v98
    v_and_b32 v125, 0xffff0000, v98
    v_lshlrev_b32 v126, 16, v99
    v_and_b32 v127, 0xffff0000, v99
    s_waitcnt lgkmcnt(0)
    s_barrier
    ds_read_b32 v128, v164
    ds_read_b32 v129, v165
    ds_read_b32 v130, v166
    ds_read_b32 v131, v167
    ds_read_b32 v132, v168
    ds_read_b32 v133, v169
    ds_read_b32 v134, v170
    ds_read_b32 v135, v171
    v_lshlrev_b32 v104, 16, v138
    v_and_b32 v105, 0xffff0000, v138
    v_lshlrev_b32 v106, 16, v139
    v_and_b32 v107, 0xffff0000, v139
    v_pk_add_f32 v[104:105], v[104:105], v[120:121]
    v_pk_add_f32 v[106:107], v[106:107], v[122:123]
    v_lshlrev_b32 v108, 16, v136
    v_and_b32 v109, 0xffff0000, v136
    v_lshlrev_b32 v110, 16, v137
    v_and_b32 v111, 0xffff0000, v137
    v_pk_add_f32 v[108:109], v[108:109], v[120:121]
    v_pk_add_f32 v[110:111], v[110:111], v[122:123]
    v_lshlrev_b32 v112, 16, v142
    v_and_b32 v113, 0xffff0000, v142
    v_lshlrev_b32 v114, 16, v143
    v_and_b32 v115, 0xffff0000, v143
    v_pk_add_f32 v[112:113], v[112:113], v[124:125]
    v_pk_add_f32 v[114:115], v[114:115], v[126:127]
    v_lshlrev_b32 v116, 16, v140
    v_and_b32 v117, 0xffff0000, v140
    v_lshlrev_b32 v118, 16, v141
    v_and_b32 v119, 0xffff0000, v141
    v_pk_add_f32 v[116:117], v[116:117], v[124:125]
    v_pk_add_f32 v[118:119], v[118:119], v[126:127]
    s_waitcnt lgkmcnt(0)
    v_mfma_f32_16x16x32_bf16 v[64:67], v[128:131], v[172:175], 0
    v_mfma_f32_16x16x32_bf16 v[68:71], v[128:131], v[176:179], 0
    v_mfma_f32_16x16x32_bf16 v[72:75], v[132:135], v[172:175], 0
    v_mfma_f32_16x16x32_bf16 v[76:79], v[132:135], v[176:179], 0
    s_mul_i32 s58, s46, 4128
    v_lshlrev_b32 v146, 1, v198
    v_lshlrev_b32 v147, 1, v199
    v_add_u32 v146, s58, v146
    v_add_u32 v147, s58, v147
    s_nop 0
    v_pk_mul_f32 v[80:81], v[68:69], v[188:189]
    v_pk_mul_f32 v[84:85], v[64:65], v[188:189]
    v_pk_mul_f32 v[82:83], v[70:71], v[190:191]
    v_pk_mul_f32 v[86:87], v[66:67], v[190:191]
    v_pk_fma_f32 v[80:81], v[64:65], v[180:181], v[80:81] neg_lo:[0,0,1] neg_hi:[0,0,1]
    v_pk_fma_f32 v[84:85], v[68:69], v[180:181], v[84:85]
    v_pk_fma_f32 v[82:83], v[66:67], v[182:183], v[82:83] neg_lo:[0,0,1] neg_hi:[0,0,1]
    v_pk_fma_f32 v[86:87], v[70:71], v[182:183], v[86:87]
    v_pk_mul_f32 v[88:89], v[76:77], v[192:193]
    v_pk_mul_f32 v[92:93], v[72:73], v[192:193]
    v_pk_mul_f32 v[90:91], v[78:79], v[194:195]
    v_pk_mul_f32 v[94:95], v[74:75], v[194:195]
    v_pk_fma_f32 v[88:89], v[72:73], v[184:185], v[88:89] neg_lo:[0,0,1] neg_hi:[0,0,1]
    v_pk_fma_f32 v[92:93], v[76:77], v[184:185], v[92:93]
    v_pk_fma_f32 v[90:91], v[74:75], v[186:187], v[90:91] neg_lo:[0,0,1] neg_hi:[0,0,1]
    v_pk_fma_f32 v[94:95], v[78:79], v[186:187], v[94:95]
    v_cvt_pk_bf16_f32 v96, v84, v85
    v_cvt_pk_bf16_f32 v97, v86, v87
    v_cvt_pk_bf16_f32 v98, v80, v81
    v_cvt_pk_bf16_f32 v99, v82, v83
    v_cvt_pk_bf16_f32 v100, v92, v93
    v_cvt_pk_bf16_f32 v101, v94, v95
    v_cvt_pk_bf16_f32 v102, v88, v89
    v_cvt_pk_bf16_f32 v103, v90, v91
    v_mfma_f32_16x16x32_bf16 v[104:107], v[96:99], v[10:13], v[104:107]
    v_mfma_f32_16x16x32_bf16 v[108:111], v[96:99], v[8:11], v[108:111]
    v_mfma_f32_16x16x32_bf16 v[112:115], v[96:99], v[22:25], v[112:115]
    v_mfma_f32_16x16x32_bf16 v[116:119], v[96:99], v[20:23], v[116:119]
    v_mfma_f32_16x16x32_bf16 v[104:107], v[100:103], v[16:19], v[104:107]
    v_mfma_f32_16x16x32_bf16 v[108:111], v[100:103], v[14:17], v[108:111]
    v_mfma_f32_16x16x32_bf16 v[112:115], v[100:103], v[28:31], v[112:115]
    v_mfma_f32_16x16x32_bf16 v[116:119], v[100:103], v[26:29], v[116:119]
    v_and_b32 v2, 7, v0
    v_lshrrev_b32 v3, 4, v0
    v_bfe_u32 v4, v0, 3, 1
    v_lshlrev_b32_e64 v5, 10, v3
    v_lshl_add_u32 v5, v4, 9, v5
    v_lshl_add_u32 v5, v2, 4, v5
    v_lshlrev_b32_e64 v6, 4, v3
    v_lshl_add_u32 v6, v4, 2, v6
    v_mul_u32_u24 v7, 2064, v2
    v_lshl_add_u32 v7, v6, 2, v7
    s_lshl_b32 s58, s46, 9
    v_add_u32 v7, s58, v7
    ds_write_b128 v146, v[104:107] offset:2064
    ds_write_b128 v146, v[108:111] offset:0
    ds_write_b128 v147, v[112:115] offset:2064
    ds_write_b128 v147, v[116:119] offset:0
    v_mul_u32_u24 v148, 272, v2
    v_lshl_add_u32 v148, v6, 1, v148
    s_mul_i32 s58, s46, 2176
    s_add_u32 s58, s58, 32768
    v_add_u32 v148, s58, v148
    v_mul_u32_u24 v149, 272, v3
    v_and_b32 v6, 15, v0
    v_lshl_add_u32 v149, v6, 4, v149
    v_add_u32 v149, s58, v149
    v_lshrrev_b32 v150, 5, v0
    v_lshlrev_b32_e64 v150, 15, v150
    v_bfe_u32 v4, v0, 4, 1
    v_lshl_add_u32 v150, v4, 20, v150
    v_lshl_add_u32 v150, v6, 4, v150
    v_and_b32 v2, 3, v0
    v_lshlrev_b32 v2, 3, v2
    s_lshr_b32 s63, s50, 2
    s_lshl_b32 s60, s63, 7
    s_lshl_b32 s58, s46, 5
    s_add_u32 s60, s60, s58
    s_add_u32 s60, s60, 32768
    buffer_load_dwordx2 v[252:253], v2, s[12:15], s60 offen sc1
    s_lshl_b32 s57, s63, 15
    s_lshl_b32 s58, s46, 13
    s_add_u32 s57, s57, s58
    s_and_b32 s58, s50, 3
    s_lshl_b32 s58, s58, 7
    s_add_u32 s57, s57, s58
    s_add_u32 s20, s57, 16777216
    s_add_u32 s21, s20, 4096
    s_add_u32 s22, s20, 2097152
    s_add_u32 s23, s20, 2101248
    s_lshr_b32 s57, s50, 5
    s_lshl_b32 s57, s57, 7
    s_and_b32 s58, s50, 31
    s_add_u32 s57, s57, s58
    s_lshl_b32 s57, s57, 10
    s_lshl_b32 s58, s46, 8
    s_add_u32 s28, s57, s58
    s_add_u32 s29, s28, 65536
    s_mov_b32 s30, 0x00003f80
    s_mov_b32 s31, 0x3f800000
    s_waitcnt lgkmcnt(0)
    s_barrier
    ds_read_b128 v[64:67], v7 offset:0
    ds_read_b128 v[68:71], v7 offset:32
    ds_read_b128 v[72:75], v7 offset:256
    ds_read_b128 v[76:79], v7 offset:288
    s_waitcnt vmcnt(0)
    v_cmp_ne_u64 vcc, s[42:43], v[252:253]
    s_nop 0
    s_cmp_lg_u64 vcc, 0
    s_cbranch_scc1 Lpa39
Lpd40:
    buffer_load_dwordx4 v[80:83], v5, s[12:15], s20 offen sc1
    buffer_load_dwordx4 v[84:87], v5, s[12:15], s21 offen sc1
    buffer_load_dwordx4 v[88:91], v5, s[12:15], s22 offen sc1
    buffer_load_dwordx4 v[92:95], v5, s[12:15], s23 offen sc1
    s_waitcnt lgkmcnt(0)
    s_waitcnt vmcnt(3)
    v_dot2c_f32_bf16 v64, s30, v80
    v_dot2c_f32_bf16 v65, s31, v80
    v_dot2c_f32_bf16 v66, s30, v81
    v_dot2c_f32_bf16 v67, s31, v81
    v_dot2c_f32_bf16 v68, s30, v82
    v_dot2c_f32_bf16 v69, s31, v82
    v_dot2c_f32_bf16 v70, s30, v83
    v_dot2c_f32_bf16 v71, s31, v83
    s_waitcnt vmcnt(2)
    v_dot2c_f32_bf16 v72, s30, v84
    v_dot2c_f32_bf16 v73, s31, v84
    v_dot2c_f32_bf16 v74, s30, v85
    v_dot2c_f32_bf16 v75, s31, v85
    v_dot2c_f32_bf16 v76, s30, v86
    v_dot2c_f32_bf16 v77, s31, v86
    v_dot2c_f32_bf16 v78, s30, v87
    v_dot2c_f32_bf16 v79, s31, v87
    s_waitcnt vmcnt(1)
    v_dot2c_f32_bf16 v64, s30, v88
    v_dot2c_f32_bf16 v65, s31, v88
    v_dot2c_f32_bf16 v66, s30, v89
    v_dot2c_f32_bf16 v67, s31, v89
    v_dot2c_f32_bf16 v68, s30, v90
    v_dot2c_f32_bf16 v69, s31, v90
    v_dot2c_f32_bf16 v70, s30, v91
    v_dot2c_f32_bf16 v71, s31, v91
    s_waitcnt vmcnt(0)
    v_dot2c_f32_bf16 v72, s30, v92
    v_dot2c_f32_bf16 v73, s31, v92
    v_dot2c_f32_bf16 v74, s30, v93
    v_dot2c_f32_bf16 v75, s31, v93
    v_dot2c_f32_bf16 v76, s30, v94
    v_dot2c_f32_bf16 v77, s31, v94
    v_dot2c_f32_bf16 v78, s30, v95
    v_dot2c_f32_bf16 v79, s31, v95
    v_cvt_pk_bf16_f32 v112, v64, v65
    v_cvt_pk_bf16_f32 v113, v66, v67
    v_cvt_pk_bf16_f32 v114, v68, v69
    v_cvt_pk_bf16_f32 v115, v70, v71
    ds_write2_b64 v148, v[112:113], v[114:115] offset0:0 offset1:2
    v_cvt_pk_bf16_f32 v116, v72, v73
    v_cvt_pk_bf16_f32 v117, v74, v75
    v_cvt_pk_bf16_f32 v118, v76, v77
    v_cvt_pk_bf16_f32 v119, v78, v79
    ds_write2_b64 v148, v[116:117], v[118:119] offset0:16 offset1:18
    s_waitcnt lgkmcnt(0)
    ds_read_b128 v[120:123], v149
    ds_read_b128 v[124:127], v149 offset:1088
    s_waitcnt lgkmcnt(1)
    buffer_store_dwordx4 v[120:123], v150, s[16:19], s28 offen sc1
    s_waitcnt lgkmcnt(0)
    buffer_store_dwordx4 v[124:127], v150, s[16:19], s29 offen sc1
    s_or_b32 s57, s2, s46
    s_cmp_lg_u32 s57, 0
    s_cbranch_scc1 Lnotag
    s_mov_b32 s60, 0
    s_mov_b64 exec, 1
    buffer_store_dwordx2 v[250:251], v249, s[12:15], s60 offen offset:0 sc1
    s_mov_b64 exec, -1
Lnotag:
Lend:
    s_endpgm
Lpa2:
    s_mov_b32 s58, 0
Lpl41:
    s_sleep 8
    buffer_load_dwordx4 v[8:11], v1, s[12:15], s3 offen sc1
    s_add_u32 s58, s58, 1
    s_waitcnt vmcnt(0)
    s_cmp_ge_u32 s58, 400000
    s_cbranch_scc1 Lpd3
    v_cmp_ne_u64 vcc, s[42:43], v[8:9]
    v_cmp_ne_u64 s[52:53], s[42:43], v[10:11]
    s_nop 0
    s_or_b64 vcc, vcc, s[52:53]
    s_cbranch_scc1 Lpl41
    s_branch Lpd3
Lpa5:
    s_mov_b32 s58, 0
Lpl42:
    s_sleep 8
    buffer_load_dwordx2 v[12:13], v15, s[12:15], s26 offen sc1
    s_add_u32 s58, s58, 1
    s_waitcnt vmcnt(0)
    s_cmp_ge_u32 s58, 400000
    s_cbranch_scc1 Lpd6
    v_cmp_ne_u64 vcc, s[42:43], v[12:13]
    s_nop 0
    s_cmp_lg_u64 vcc, 0
    s_cbranch_scc1 Lpl42
    s_branch Lpd6
Lcs11:
Lls43:
    s_sleep 1
    ds_read2_b32 v[138:139], v254 offset0:64 offset1:128
    s_waitcnt lgkmcnt(0)
    v_min_u32 v138, v138, v139
    s_nop 0
    v_readfirstlane_b32 s58, v138
    s_add_u32 s55, s55, 1
    s_lshr_b32 s54, s55, 24
    s_lshl_b32 s54, s54, 8
    s_or_b32 s58, s58, s54
    s_cmp_lt_u32 s58, 2
    s_cbranch_scc1 Lls43
    s_branch Lcb12
Lcs13:
Lls44:
    s_sleep 1
    ds_read2_b32 v[138:139], v254 offset0:64 offset1:128
    s_waitcnt lgkmcnt(0)
    v_min_u32 v138, v138, v139
    s_nop 0
    v_readfirstlane_b32 s58, v138
    s_add_u32 s55, s55, 1
    s_lshr_b32 s54, s55, 24
    s_lshl_b32 s54, s54, 8
    s_or_b32 s58, s58, s54
    s_cmp_lt_u32 s58, 3
    s_cbranch_scc1 Lls44
    s_branch Lcb14
Lcs15:
Lls45:
    s_sleep 1
    ds_read2_b32 v[138:139], v254 offset0:64 offset1:128
    s_waitcnt lgkmcnt(0)
    v_min_u32 v138, v138, v139
    s_nop 0
    v_readfirstlane_b32 s58, v138
    s_add_u32 s55, s55, 1
    s_lshr_b32 s54, s55, 24
    s_lshl_b32 s54, s54, 8
    s_or_b32 s58, s58, s54
    s_cmp_lt_u32 s58, 4
    s_cbranch_scc1 Lls45
    s_branch Lcb16
Lcs17:
Lls46:
    s_sleep 1
    ds_read2_b32 v[138:139], v254 offset0:64 offset1:128
    s_waitcnt lgkmcnt(0)
    v_min_u32 v138, v138, v139
    s_nop 0
    v_readfirstlane_b32 s58, v138
    s_add_u32 s55, s55, 1
    s_lshr_b32 s54, s55, 24
    s_lshl_b32 s54, s54, 8
    s_or_b32 s58, s58, s54
    s_cmp_lt_u32 s58, 5
    s_cbranch_scc1 Lls46
    s_branch Lcb18
Lcs19:
Lls47:
    s_sleep 1
    ds_read2_b32 v[138:139], v254 offset0:64 offset1:128
    s_waitcnt lgkmcnt(0)
    v_min_u32 v138, v138, v139
    s_nop 0
    v_readfirstlane_b32 s58, v138
    s_add_u32 s55, s55, 1
    s_lshr_b32 s54, s55, 24
    s_lshl_b32 s54, s54, 8
    s_or_b32 s58, s58, s54
    s_cmp_lt_u32 s58, 6
    s_cbranch_scc1 Lls47
    s_branch Lcb20
Lcs21:
Lls48:
    s_sleep 1
    ds_read2_b32 v[138:139], v254 offset0:64 offset1:128
    s_waitcnt lgkmcnt(0)
    v_min_u32 v138, v138, v139
    s_nop 0
    v_readfirstlane_b32 s58, v138
    s_add_u32 s55, s55, 1
    s_lshr_b32 s54, s55, 24
    s_lshl_b32 s54, s54, 8
    s_or_b32 s58, s58, s54
    s_cmp_lt_u32 s58, 7
    s_cbranch_scc1 Lls48
    s_branch Lcb22
Lcs23:
Lls49:
    s_sleep 1
    ds_read2_b32 v[138:139], v254 offset0:64 offset1:128
    s_waitcnt lgkmcnt(0)
    v_min_u32 v138, v138, v139
    s_nop 0
    v_readfirstlane_b32 s58, v138
    s_add_u32 s55, s55, 1
    s_lshr_b32 s54, s55, 24
    s_lshl_b32 s54, s54, 8
    s_or_b32 s58, s58, s54
    s_cmp_lt_u32 s58, 8
    s_cbranch_scc1 Lls49
    s_branch Lcb24
Lcs25:
Lls50:
    s_sleep 1
    ds_read2_b32 v[138:139], v254 offset0:64 offset1:128
    s_waitcnt lgkmcnt(0)
    v_min_u32 v138, v138, v139
    s_nop 0
    v_readfirstlane_b32 s58, v138
    s_add_u32 s55, s55, 1
    s_lshr_b32 s54, s55, 24
    s_lshl_b32 s54, s54, 8
    s_or_b32 s58, s58, s54
    s_cmp_lt_u32 s58, 9
    s_cbranch_scc1 Lls50
    s_branch Lcb26
Lext_slow:
    v_and_b32 v2, 31, v0
    v_lshlrev_b32 v2, 4, v2
    s_lshl_b32 s57, s47, 11
    s_lshl_b32 s58, s64, 10
    s_add_u32 s57, s57, s58
    s_add_u32 s38, s57, 524288
    s_add_u32 s39, s38, 0x8000
    s_lshl_b32 s57, s62, 14
    s_lshr_b32 s58, s47, 2
    s_lshl_b32 s58, s58, 12
    s_add_u32 s57, s57, s58
    s_lshl_b32 s58, s59, 5
    s_add_u32 s57, s57, s58
    s_add_u32 s57, s57, 262144
    s_mov_b32 s58, 0
Lext_lp:
    s_sleep 4
    buffer_load_dwordx4 v[140:143], v1, s[12:15], s38 offen sc1
    buffer_load_dwordx4 v[144:147], v2, s[12:15], s39 offen offset:0 sc1
    buffer_load_dwordx4 v[148:151], v2, s[12:15], s39 offen offset:512 sc1
    buffer_load_dwordx4 v[204:207], v199, s[12:15], s57 offen offset:0 sc1
    buffer_load_dwordx4 v[208:211], v199, s[12:15], s57 offen offset:1024 sc1
    buffer_load_dwordx4 v[212:215], v199, s[12:15], s57 offen offset:2048 sc1
    buffer_load_dwordx4 v[216:219], v199, s[12:15], s57 offen offset:3072 sc1
    s_add_u32 s58, s58, 1
    s_waitcnt vmcnt(0)
    v_xor_b32 v143, s42, v143
    v_xor_b32 v147, s42, v147
    v_xor_b32 v151, s42, v151
    v_xor_b32 v206, s42, v206
    v_xor_b32 v210, s42, v210
    v_xor_b32 v214, s42, v214
    v_xor_b32 v218, s42, v218
    v_or3_b32 v138, v143, v147, v151
    v_or3_b32 v138, v138, v206, v210
    v_or3_b32 v138, v138, v214, v218
    v_cmp_ne_u32 vcc, 0, v138
    s_cmp_ge_u32 s58, 400000
    s_cbranch_scc1 Lext_ok
    s_cmp_lg_u64 vcc, 0
    s_cbranch_scc1 Lext_lp
    s_branch Lext_ok
Lhelper:
    s_waitcnt lgkmcnt(0)
    s_barrier
    s_add_u32 s42, s42, 0x9e3779b9
    s_addc_u32 s43, s43, 0x7f4a7c15
    s_lshl_b32 s67, s44, 2
    s_and_b32 s58, s45, 3
    s_add_u32 s67, s67, s58
    v_bfe_u32 v2, v0, 3, 1
    v_bfe_u32 v3, v0, 2, 1
    v_lshl_add_u32 v2, v3, 5, v2
    v_and_b32_e64 v3, 3, v0
    v_lshl_add_u32 v2, v3, 3, v2
    v_mul_u32_u24 v2, 514, v2
    v_lshrrev_b32 v3, 4, v0
    s_lshl_b32 s58, s46, 6
    v_add_u32 v3, s58, v3
    v_lshl_add_u32 v4, v3, 1, v2
    v_cmp_eq_u32 vcc, 0, v3
    v_add_u32 v5, 512, v4
    s_nop 0
    v_cndmask_b32 v5, v4, v5, vcc
    v_mul_u32_u24 v3, 8320, v3
    v_and_b32 v6, 15, v0
    v_lshl_add_u32 v3, v6, 4, v3
    s_lshl_b32 s68, s67, 8
    s_add_u32 s68, s68, 3407872
    v_cos_f32 v152, v160
    v_cos_f32 v153, v161
    v_cos_f32 v154, v162
    v_cos_f32 v155, v163
    v_cos_f32 v156, v164
    v_cos_f32 v157, v165
    v_cos_f32 v158, v166
    v_cos_f32 v159, v167
    v_sin_f32 v160, v160
    v_sin_f32 v161, v161
    v_sin_f32 v162, v162
    v_sin_f32 v163, v163
    v_sin_f32 v164, v164
    v_sin_f32 v165, v165
    v_sin_f32 v166, v166
    v_sin_f32 v167, v167
    v_mul_f32 v172, v195, v208
    v_mul_f32 v173, v195, v209
    v_mul_f32 v174, v195, v210
    v_mul_f32 v175, v195, v211
    v_cos_f32 v168, v172
    v_cos_f32 v169, v173
    v_cos_f32 v170, v174
    v_cos_f32 v171, v175
    v_sin_f32 v172, v172
    v_sin_f32 v173, v173
    v_sin_f32 v174, v174
    v_sin_f32 v175, v175
    v_lshrrev_b32 v192, 5, v0
    v_lshlrev_b32 v192, 7, v192
    v_bfe_u32 v193, v0, 1, 4
    v_add_u32 v192, v192, v193
    v_and_b32 v193, 1, v0
    v_lshl_add_u32 v192, v193, 6, v192
    s_lshl_b32 s53, s64, 9
    s_add_u32 s53, s53, s59
    v_add_u32 v192, s53, v192
    v_cvt_f32_u32 v192, v192
    v_mul_f32 v220, 0x3a000000, v192
    v_add_f32 v221, 0x3c800000, v220
    v_add_f32 v222, 0x3e000000, v220
    v_add_f32 v223, 0x3e100000, v220
    v_cos_f32 v224, v220
    v_cos_f32 v225, v221
    v_cos_f32 v226, v222
    v_cos_f32 v227, v223
    v_sin_f32 v220, v220
    v_sin_f32 v221, v221
    v_sin_f32 v222, v222
    v_sin_f32 v223, v223
    v_add_f32 v228, v224, v220
    v_add_f32 v229, v225, v221
    v_add_f32 v230, v226, v222
    v_add_f32 v231, v227, v223
    v_sub_f32 v220, v224, v220
    v_sub_f32 v221, v225, v221
    v_sub_f32 v222, v226, v222
    v_sub_f32 v223, v227, v223
    v_cvt_pk_bf16_f32 v176, v228, v220
    v_cvt_pk_bf16_f32 v180, v220, v228
    v_cvt_pk_bf16_f32 v177, v229, v221
    v_cvt_pk_bf16_f32 v181, v221, v229
    v_cvt_pk_bf16_f32 v178, v230, v222
    v_cvt_pk_bf16_f32 v182, v222, v230
    v_cvt_pk_bf16_f32 v179, v231, v223
    v_cvt_pk_bf16_f32 v183, v223, v231
    v_lshrrev_b32 v193, 5, v0
    v_lshlrev_b32 v193, 5, v193
    v_bfe_u32 v194, v0, 1, 4
    v_add_u32 v193, v193, v194
    v_lshlrev_b32 v130, 5, v193
    v_and_b32 v194, 1, v0
    v_lshl_add_u32 v130, v194, 4, v130
    v_lshrrev_b32 v193, 1, v0
    v_lshlrev_b32 v193, 4, v193
    v_lshl_add_u32 v190, v194, 3, v193
    s_lshl_b32 s53, s46, 10
    s_add_u32 s52, s53, 139264
    v_add_u32 v190, s52, v190
    s_add_u32 s52, s53, 147456
    v_add_u32 v188, s52, v1
    v_xor_b32 v189, 1024, v188
    s_lshl_b32 s53, s64, 12
    s_mul_i32 s52, s59, 192
    s_add_u32 s52, s53, s52
    s_add_u32 s52, s52, 139264
    v_add_u32_e64 v184, s52, v1
    v_xor_b32 v185, 1024, v184
    v_xor_b32 v186, 2048, v184
    v_xor_b32 v187, 3072, v184
    v_lshl_add_u32 v196, v194, 2, v193
    s_lshl_b32 s53, s46, 10
    s_add_u32 s52, s53, 139264
    v_add_u32 v196, s52, v196
    v_add_u32 v197, 4096, v196
    v_add_u32 v128, s52, v1
    v_lshlrev_b32 v194, 8, v133
    v_lshl_add_u32 v129, v132, 2, v194
    s_lshl_b32 s52, s59, 8
    s_lshl_b32 s53, s46, 6
    s_add_u32 s53, s53, s52
    s_add_u32 s53, s53, 114688
    v_add_u32 v129, s53, v129
    v_xor_b32 v191, 4096, v129
    s_lshl_b32 s53, s64, 7
    s_add_u32 s66, s53, s59
    s_lshl_b32 s66, s66, 5
    s_mul_i32 s53, s51, 8320
    s_add_u32 s66, s66, s53
    s_add_u32 s66, s66, 5767168
    s_lshl_b32 s63, s47, 2
    s_add_u32 s63, s63, s46
    s_mul_i32 s65, s63, 114688
    s_mul_i32 s53, s49, 57344
    s_add_u32 s65, s65, s53
    s_add_u32 s65, s65, 8388608
    s_and_b32 s52, s45, 3
    s_lshl_b32 s52, s52, 1
    s_add_u32 s52, s52, s48
    s_sub_u32 s53, s52, 7
    s_cmp_ge_u32 s52, 7
    s_cselect_b32 s52, s53, s52
    s_lshl_b32 s53, s52, 13
    s_add_u32 s20, s65, s53
    s_add_u32 s21, s20, 4096
    s_add_u32 s52, s52, 1
    s_cmp_eq_u32 s52, 7
    s_cselect_b32 s52, 0, s52
    s_lshl_b32 s53, s52, 13
    s_add_u32 s22, s65, s53
    s_add_u32 s23, s22, 4096
    s_add_u32 s52, s52, 1
    s_cmp_eq_u32 s52, 7
    s_cselect_b32 s52, 0, s52
    s_lshl_b32 s53, s52, 13
    s_add_u32 s24, s65, s53
    s_add_u32 s25, s24, 4096
    s_add_u32 s52, s52, 1
    s_cmp_eq_u32 s52, 7
    s_cselect_b32 s52, 0, s52
    s_lshl_b32 s53, s52, 13
    s_add_u32 s26, s65, s53
    s_add_u32 s27, s26, 4096
    s_add_u32 s52, s52, 1
    s_cmp_eq_u32 s52, 7
    s_cselect_b32 s52, 0, s52
    s_lshl_b32 s53, s52, 13
    s_add_u32 s28, s65, s53
    s_add_u32 s29, s28, 4096
    s_add_u32 s52, s52, 1
    s_cmp_eq_u32 s52, 7
    s_cselect_b32 s52, 0, s52
    s_lshl_b32 s53, s52, 13
    s_add_u32 s30, s65, s53
    s_add_u32 s31, s30, 4096
    s_add_u32 s52, s52, 1
    s_cmp_eq_u32 s52, 7
    s_cselect_b32 s52, 0, s52
    s_lshl_b32 s53, s52, 13
    s_add_u32 s32, s65, s53
    s_add_u32 s33, s32, 4096
    s_lshl_b32 s61, s47, 1
    s_add_u32 s61, s61, s49
    s_lshl_b32 s61, s61, 1
    s_add_u32 s61, s61, s64
    s_lshl_b32 s61, s61, 8
    s_add_u32 s61, s61, 40960
    s_lshl_b32 s53, s48, 4
    s_add_u32 s60, s61, s53
    s_lshr_b32 s53, s59, 1
    s_add_u32 s60, s60, s53
    v_min_u32 v132, 13, v0
    v_lshlrev_b32 v132, 3, v132
    v_lshlrev_b32 v248, 3, v0
    v_mov_b32 v250, s42
    v_mov_b32 v251, s43
    v_mov_b32 v249, 0
Lls51:
    s_sleep 2
    ds_read2_b32 v[138:139], v254 offset0:64 offset1:128
    s_waitcnt lgkmcnt(0)
    v_min_u32 v138, v138, v139
    s_nop 0
    v_readfirstlane_b32 s58, v138
    s_add_u32 s55, s55, 1
    s_lshr_b32 s54, s55, 24
    s_lshl_b32 s54, s54, 8
    s_or_b32 s58, s58, s54
    s_cmp_lt_u32 s58, 1
    s_cbranch_scc1 Lls51
    ds_read_u16 v32, v5 offset:0
    ds_read_u16 v36, v5 offset:36864
    ds_read_u16 v33, v5 offset:1028
    ds_read_u16 v37, v5 offset:37892
    ds_read_u16 v34, v5 offset:2056
    ds_read_u16 v38, v5 offset:38920
    ds_read_u16 v35, v5 offset:3084
    ds_read_u16 v39, v5 offset:39948
    ds_read_u16 v40, v4 offset:8
    ds_read_u16 v44, v4 offset:36872
    ds_read_u16 v41, v4 offset:1036
    ds_read_u16 v45, v4 offset:37900
    ds_read_u16 v42, v4 offset:2064
    ds_read_u16 v46, v4 offset:38928
    ds_read_u16 v43, v4 offset:3092
    ds_read_u16 v47, v4 offset:39956
    s_waitcnt lgkmcnt(8)
    v_lshl_or_b32 v64, v36, 16, v32
    v_lshl_or_b32 v65, v37, 16, v33
    v_lshl_or_b32 v66, v38, 16, v34
    v_lshl_or_b32 v67, v39, 16, v35
    buffer_store_dwordx4 v[64:67], v3, s[12:15], s68 offen sc1
    s_add_u32 s68, s68, 33280
    ds_read_u16 v48, v4 offset:16
    ds_read_u16 v52, v4 offset:36880
    ds_read_u16 v49, v4 offset:1044
    ds_read_u16 v53, v4 offset:37908
    ds_read_u16 v50, v4 offset:2072
    ds_read_u16 v54, v4 offset:38936
    ds_read_u16 v51, v4 offset:3100
    ds_read_u16 v55, v4 offset:39964
    s_waitcnt lgkmcnt(8)
    v_lshl_or_b32 v68, v44, 16, v40
    v_lshl_or_b32 v69, v45, 16, v41
    v_lshl_or_b32 v70, v46, 16, v42
    v_lshl_or_b32 v71, v47, 16, v43
    buffer_store_dwordx4 v[68:71], v3, s[12:15], s68 offen sc1
    s_add_u32 s68, s68, 33280
    ds_read_u16 v32, v4 offset:24
    ds_read_u16 v36, v4 offset:36888
    ds_read_u16 v33, v4 offset:1052
    ds_read_u16 v37, v4 offset:37916
    ds_read_u16 v34, v4 offset:2080
    ds_read_u16 v38, v4 offset:38944
    ds_read_u16 v35, v4 offset:3108
    ds_read_u16 v39, v4 offset:39972
    s_waitcnt lgkmcnt(8)
    v_lshl_or_b32 v72, v52, 16, v48
    v_lshl_or_b32 v73, v53, 16, v49
    v_lshl_or_b32 v74, v54, 16, v50
    v_lshl_or_b32 v75, v55, 16, v51
    buffer_store_dwordx4 v[72:75], v3, s[12:15], s68 offen sc1
    s_add_u32 s68, s68, 33280
    ds_read_u16 v40, v4 offset:32
    ds_read_u16 v44, v4 offset:36896
    ds_read_u16 v41, v4 offset:1060
    ds_read_u16 v45, v4 offset:37924
    ds_read_u16 v42, v4 offset:2088
    ds_read_u16 v46, v4 offset:38952
    ds_read_u16 v43, v4 offset:3116
    ds_read_u16 v47, v4 offset:39980
    s_waitcnt lgkmcnt(8)
    v_lshl_or_b32 v76, v36, 16, v32
    v_lshl_or_b32 v77, v37, 16, v33
    v_lshl_or_b32 v78, v38, 16, v34
    v_lshl_or_b32 v79, v39, 16, v35
    buffer_store_dwordx4 v[76:79], v3, s[12:15], s68 offen sc1
    s_add_u32 s68, s68, 33280
    ds_read_u16 v48, v4 offset:40
    ds_read_u16 v52, v4 offset:36904
    ds_read_u16 v49, v4 offset:1068
    ds_read_u16 v53, v4 offset:37932
    ds_read_u16 v50, v4 offset:2096
    ds_read_u16 v54, v4 offset:38960
    ds_read_u16 v51, v4 offset:3124
    ds_read_u16 v55, v4 offset:39988
    s_waitcnt lgkmcnt(8)
    v_lshl_or_b32 v64, v44, 16, v40
    v_lshl_or_b32 v65, v45, 16, v41
    v_lshl_or_b32 v66, v46, 16, v42
    v_lshl_or_b32 v67, v47, 16, v43
    buffer_store_dwordx4 v[64:67], v3, s[12:15], s68 offen sc1
    s_add_u32 s68, s68, 33280
    ds_read_u16 v32, v4 offset:48
    ds_read_u16 v36, v4 offset:36912
    ds_read_u16 v33, v4 offset:1076
    ds_read_u16 v37, v4 offset:37940
    ds_read_u16 v34, v4 offset:2104
    ds_read_u16 v38, v4 offset:38968
    ds_read_u16 v35, v4 offset:3132
    ds_read_u16 v39, v4 offset:39996
    s_waitcnt lgkmcnt(8)
    v_lshl_or_b32 v68, v52, 16, v48
    v_lshl_or_b32 v69, v53, 16, v49
    v_lshl_or_b32 v70, v54, 16, v50
    v_lshl_or_b32 v71, v55, 16, v51
    buffer_store_dwordx4 v[68:71], v3, s[12:15], s68 offen sc1
    s_add_u32 s68, s68, 33280
    ds_read_u16 v40, v4 offset:56
    ds_read_u16 v44, v4 offset:36920
    ds_read_u16 v41, v4 offset:1084
    ds_read_u16 v45, v4 offset:37948
    ds_read_u16 v42, v4 offset:2112
    ds_read_u16 v46, v4 offset:38976
    ds_read_u16 v43, v4 offset:3140
    ds_read_u16 v47, v4 offset:40004
    s_waitcnt lgkmcnt(8)
    v_lshl_or_b32 v72, v36, 16, v32
    v_lshl_or_b32 v73, v37, 16, v33
    v_lshl_or_b32 v74, v38, 16, v34
    v_lshl_or_b32 v75, v39, 16, v35
    buffer_store_dwordx4 v[72:75], v3, s[12:15], s68 offen sc1
    s_add_u32 s68, s68, 33280
    ds_read_u16 v48, v4 offset:64
    ds_read_u16 v52, v4 offset:36928
    ds_read_u16 v49, v4 offset:1092
    ds_read_u16 v53, v4 offset:37956
    ds_read_u16 v50, v4 offset:2120
    ds_read_u16 v54, v4 offset:38984
    ds_read_u16 v51, v4 offset:3148
    ds_read_u16 v55, v4 offset:40012
    s_waitcnt lgkmcnt(8)
    v_lshl_or_b32 v76, v44, 16, v40
    v_lshl_or_b32 v77, v45, 16, v41
    v_lshl_or_b32 v78, v46, 16, v42
    v_lshl_or_b32 v79, v47, 16, v43
    buffer_store_dwordx4 v[76:79], v3, s[12:15], s68 offen sc1
    s_add_u32 s68, s68, 33280
    ds_read_u16 v32, v4 offset:72
    ds_read_u16 v36, v4 offset:36936
    ds_read_u16 v33, v4 offset:1100
    ds_read_u16 v37, v4 offset:37964
    ds_read_u16 v34, v4 offset:2128
    ds_read_u16 v38, v4 offset:38992
    ds_read_u16 v35, v4 offset:3156
    ds_read_u16 v39, v4 offset:40020
    s_waitcnt lgkmcnt(8)
    v_lshl_or_b32 v64, v52, 16, v48
    v_lshl_or_b32 v65, v53, 16, v49
    v_lshl_or_b32 v66, v54, 16, v50
    v_lshl_or_b32 v67, v55, 16, v51
    buffer_store_dwordx4 v[64:67], v3, s[12:15], s68 offen sc1
    s_add_u32 s68, s68, 33280
    ds_read_u16 v40, v4 offset:80
    ds_read_u16 v44, v4 offset:36944
    ds_read_u16 v41, v4 offset:1108
    ds_read_u16 v45, v4 offset:37972
    ds_read_u16 v42, v4 offset:2136
    ds_read_u16 v46, v4 offset:39000
    ds_read_u16 v43, v4 offset:3164
    ds_read_u16 v47, v4 offset:40028
    s_waitcnt lgkmcnt(8)
    v_lshl_or_b32 v68, v36, 16, v32
    v_lshl_or_b32 v69, v37, 16, v33
    v_lshl_or_b32 v70, v38, 16, v34
    v_lshl_or_b32 v71, v39, 16, v35
    buffer_store_dwordx4 v[68:71], v3, s[12:15], s68 offen sc1
    s_add_u32 s68, s68, 33280
    ds_read_u16 v48, v4 offset:88
    ds_read_u16 v52, v4 offset:36952
    ds_read_u16 v49, v4 offset:1116
    ds_read_u16 v53, v4 offset:37980
    ds_read_u16 v50, v4 offset:2144
    ds_read_u16 v54, v4 offset:39008
    ds_read_u16 v51, v4 offset:3172
    ds_read_u16 v55, v4 offset:40036
    s_waitcnt lgkmcnt(8)
    v_lshl_or_b32 v72, v44, 16, v40
    v_lshl_or_b32 v73, v45, 16, v41
    v_lshl_or_b32 v74, v46, 16, v42
    v_lshl_or_b32 v75, v47, 16, v43
    buffer_store_dwordx4 v[72:75], v3, s[12:15], s68 offen sc1
    s_add_u32 s68, s68, 33280
    ds_read_u16 v32, v4 offset:96
    ds_read_u16 v36, v4 offset:36960
    ds_read_u16 v33, v4 offset:1124
    ds_read_u16 v37, v4 offset:37988
    ds_read_u16 v34, v4 offset:2152
    ds_read_u16 v38, v4 offset:39016
    ds_read_u16 v35, v4 offset:3180
    ds_read_u16 v39, v4 offset:40044
    s_waitcnt lgkmcnt(8)
    v_lshl_or_b32 v76, v52, 16, v48
    v_lshl_or_b32 v77, v53, 16, v49
    v_lshl_or_b32 v78, v54, 16, v50
    v_lshl_or_b32 v79, v55, 16, v51
    buffer_store_dwordx4 v[76:79], v3, s[12:15], s68 offen sc1
    s_add_u32 s68, s68, 33280
    ds_read_u16 v40, v4 offset:104
    ds_read_u16 v44, v4 offset:36968
    ds_read_u16 v41, v4 offset:1132
    ds_read_u16 v45, v4 offset:37996
    ds_read_u16 v42, v4 offset:2160
    ds_read_u16 v46, v4 offset:39024
    ds_read_u16 v43, v4 offset:3188
    ds_read_u16 v47, v4 offset:40052
    s_waitcnt lgkmcnt(8)
    v_lshl_or_b32 v64, v36, 16, v32
    v_lshl_or_b32 v65, v37, 16, v33
    v_lshl_or_b32 v66, v38, 16, v34
    v_lshl_or_b32 v67, v39, 16, v35
    buffer_store_dwordx4 v[64:67], v3, s[12:15], s68 offen sc1
    s_add_u32 s68, s68, 33280
    ds_read_u16 v48, v4 offset:112
    ds_read_u16 v52, v4 offset:36976
    ds_read_u16 v49, v4 offset:1140
    ds_read_u16 v53, v4 offset:38004
    ds_read_u16 v50, v4 offset:2168
    ds_read_u16 v54, v4 offset:39032
    ds_read_u16 v51, v4 offset:3196
    ds_read_u16 v55, v4 offset:40060
    s_waitcnt lgkmcnt(8)
    v_lshl_or_b32 v68, v44, 16, v40
    v_lshl_or_b32 v69, v45, 16, v41
    v_lshl_or_b32 v70, v46, 16, v42
    v_lshl_or_b32 v71, v47, 16, v43
    buffer_store_dwordx4 v[68:71], v3, s[12:15], s68 offen sc1
    s_add_u32 s68, s68, 33280
    ds_read_u16 v32, v4 offset:120
    ds_read_u16 v36, v4 offset:36984
    ds_read_u16 v33, v4 offset:1148
    ds_read_u16 v37, v4 offset:38012
    ds_read_u16 v34, v4 offset:2176
    ds_read_u16 v38, v4 offset:39040
    ds_read_u16 v35, v4 offset:3204
    ds_read_u16 v39, v4 offset:40068
    s_waitcnt lgkmcnt(8)
    v_lshl_or_b32 v72, v52, 16, v48
    v_lshl_or_b32 v73, v53, 16, v49
    v_lshl_or_b32 v74, v54, 16, v50
    v_lshl_or_b32 v75, v55, 16, v51
    buffer_store_dwordx4 v[72:75], v3, s[12:15], s68 offen sc1
    s_add_u32 s68, s68, 33280
    s_waitcnt lgkmcnt(0)
    v_lshl_or_b32 v76, v36, 16, v32
    v_lshl_or_b32 v77, v37, 16, v33
    v_lshl_or_b32 v78, v38, 16, v34
    v_lshl_or_b32 v79, v39, 16, v35
    buffer_store_dwordx4 v[76:79], v3, s[12:15], s68 offen sc1
    s_add_u32 s68, s68, 33280
    s_lshl_b32 s68, s46, 8
    s_lshl_b32 s67, s67, 3
    s_add_u32 s68, s68, s67
    s_add_u32 s68, s68, 12288
    s_waitcnt vmcnt(0)
    s_mov_b64 exec, 1
    buffer_store_dwordx2 v[250:251], v249, s[12:15], s68 offen offset:0 sc1
    s_mov_b64 exec, -1
    v_mov_b32 v2, 8
    ds_write_b32 v131, v2 offset:16
    v_mov_b64 v[138:139], 0
    s_branch Lcol
Lcs27:
Lls52:
    s_sleep 1
    ds_read2_b32 v[138:139], v254 offset0:64 offset1:128
    s_waitcnt lgkmcnt(0)
    v_min_u32 v138, v138, v139
    s_nop 0
    v_readfirstlane_b32 s58, v138
    s_add_u32 s55, s55, 1
    s_lshr_b32 s54, s55, 24
    s_lshl_b32 s54, s54, 8
    s_or_b32 s58, s58, s54
    s_cmp_lt_u32 s58, 10
    s_cbranch_scc1 Lls52
    ds_read_b128 v[240:243], v128
    ds_read_b128 v[244:247], v128 offset:4096
    s_waitcnt lgkmcnt(0)
    s_branch Lcb28
Lcs29:
Lls53:
    s_sleep 1
    ds_read_b32 v138, v254 offset:512
    s_waitcnt lgkmcnt(0)
    v_readfirstlane_b32 s58, v138
    s_add_u32 s55, s55, 1
    s_lshr_b32 s54, s55, 24
    s_lshl_b32 s54, s54, 8
    s_or_b32 s58, s58, s54
    s_cmp_lt_u32 s58, 11
    s_cbranch_scc1 Lls53
    ds_read2_b32 v[200:201], v129 offset0:0 offset1:64
    ds_read2_b32 v[202:203], v129 offset0:128 offset1:192
    ds_read2_b32 v[204:205], v191 offset0:0 offset1:64
    ds_read2_b32 v[206:207], v191 offset0:128 offset1:192
    s_waitcnt lgkmcnt(0)
    s_branch Lcb30
Lpa31:
    s_mov_b32 s58, 0
Lpl54:
    s_sleep 4
    buffer_load_dwordx2 v[252:253], v132, s[12:15], s61 offen sc1
    s_add_u32 s58, s58, 1
    s_waitcnt vmcnt(0)
    s_cmp_ge_u32 s58, 400000
    s_cbranch_scc1 Lpd32
    v_cmp_ne_u64 vcc, s[42:43], v[252:253]
    s_nop 0
    s_cmp_lg_u64 vcc, 0
    s_cbranch_scc1 Lpl54
    s_branch Lpd32
Lk0:
    v_pk_add_f32 v[74:75], v[74:75], v[72:73]
    v_pk_mul_f32 v[74:75], v[74:75], 0.5 op_sel_hi:[1,0]
    v_mov_b64_e64 v[72:73], 0
    v_pk_add_f32 v[78:79], v[78:79], v[76:77]
    v_pk_mul_f32 v[78:79], v[78:79], 0.5 op_sel_hi:[1,0]
    v_mov_b64_e64 v[76:77], 0
    v_pk_add_f32 v[82:83], v[82:83], v[80:81]
    v_pk_mul_f32 v[82:83], v[82:83], 0.5 op_sel_hi:[1,0]
    v_mov_b64_e64 v[80:81], 0
    v_pk_add_f32 v[86:87], v[86:87], v[84:85]
    v_pk_mul_f32 v[86:87], v[86:87], 0.5 op_sel_hi:[1,0]
    v_mov_b64 v[84:85], 0
    s_branch Lnk0
Lcs33:
Lls55:
    s_sleep 1
    ds_read2_b32 v[128:129], v254 offset0:64 offset1:128
    s_waitcnt lgkmcnt(0)
    v_min_u32 v128, v128, v129
    s_nop 0
    v_readfirstlane_b32 s58, v128
    s_add_u32 s55, s55, 1
    s_lshr_b32 s54, s55, 24
    s_lshl_b32 s54, s54, 8
    s_or_b32 s58, s58, s54
    s_cmp_lt_u32 s58, 11
    s_cbranch_scc1 Lls55
    s_branch Lcb34
Lpa35:
    s_mov_b32 s58, 0
Lpl56:
    s_sleep 2
    buffer_load_dwordx2 v[252:253], v5, s[12:15], s61 offen sc1
    s_add_u32 s58, s58, 1
    s_waitcnt vmcnt(0)
    s_cmp_ge_u32 s58, 400000
    s_cbranch_scc1 Lpd36
    v_cmp_ne_u64 vcc, s[42:43], v[252:253]
    s_nop 0
    s_cmp_lg_u64 vcc, 0
    s_cbranch_scc1 Lpl56
    s_branch Lpd36
Lpa37:
    s_mov_b32 s58, 0
Lpl57:
    s_sleep 4
    buffer_load_dwordx2 v[252:253], v7, s[12:15], s65 offen sc1
    s_add_u32 s58, s58, 1
    s_waitcnt vmcnt(0)
    s_cmp_ge_u32 s58, 400000
    s_cbranch_scc1 Lpd38
    v_cmp_ne_u64 vcc, s[42:43], v[252:253]
    s_nop 0
    s_cmp_lg_u64 vcc, 0
    s_cbranch_scc1 Lpl57
    s_branch Lpd38
Lpa39:
    s_mov_b32 s58, 0
Lpl58:
    s_sleep 2
    buffer_load_dwordx2 v[252:253], v2, s[12:15], s60 offen sc1
    s_add_u32 s58, s58, 1
    s_waitcnt vmcnt(0)
    s_cmp_ge_u32 s58, 400000
    s_cbranch_scc1 Lpd40
    v_cmp_ne_u64 vcc, s[42:43], v[252:253]
    s_nop 0
    s_cmp_lg_u64 vcc, 0
    s_cbranch_scc1 Lpl58
    s_branch Lpd40
.type Ltab,@object
Ltab:
.long 0, 1, 2, 3, 4, 5, 6, 7, 8, 9, 10, 11, 12, 13, 14, 15
Lcode_end:
.section .rodata,"a"
.p2align 6
.amdhsa_kernel parallel_sum__spectral_gfnet__mixer_channel_mlp__prompt_kernel
  .amdhsa_next_free_vgpr 256
  .amdhsa_next_free_sgpr 102
  .amdhsa_accum_offset 256
  .amdhsa_group_segment_fixed_size 0
  .amdhsa_kernarg_size 88
  .amdhsa_user_sgpr_count 2
  .amdhsa_user_sgpr_kernarg_segment_ptr 1
  .amdhsa_system_sgpr_workgroup_id_x 1
.end_amdhsa_kernel
```
